```python
import torch

def _softmax(x, axis=-1):
    return torch.softmax(x, dim=axis)
def _gelu(x):
    return torch.nn.functional.gelu(x, approximate="tanh")
def _silu(x):
    return torch.nn.functional.silu(x)
def _sigmoid(x):
    return torch.sigmoid(x)
def _layernorm(x, axis=-1, eps=1e-5):
    m = x.mean(dim=axis, keepdim=True)
    v = x.var(dim=axis, keepdim=True, unbiased=False)
    return (x - m) / torch.sqrt(v + eps)
def _scatter_add(tgt, idx, src, axis=0):
    return tgt.clone().index_add_(axis, idx, src)
def _segment_sum(src, seg, n):
    out = torch.zeros((n,) + src.shape[1:], dtype=src.dtype)
    return out.index_add_(0, seg, src)
def _pad(x, pw):
    flat = tuple(v for pair in reversed(pw) for v in pair)
    return torch.nn.functional.pad(x, flat)

kernel_name = 'interleave_layers__linear_kernel_hedgehog__grouped_kv_mqa__prompt'

def setup_inputs():

    _w = (lambda a: (lambda t: t.to(torch.bfloat16) if t.is_floating_point() else t)(torch.as_tensor(a)))
    def _A_setup():
        B, S, D, H = 1, 2048, 1024, 32
        Dh = D // H
        return {
            "x": _w((lambda *s: torch.randn(*s, dtype=torch.bfloat16) * 0.05)(B, S, D)),
            "wqkv": _w((lambda *s: torch.randn(*s, dtype=torch.bfloat16) * 0.2)(D, 3 * D)),
            "w_phi": _w((lambda *s: torch.randn(*s, dtype=torch.bfloat16) * 0.2)(H, Dh, Dh) * (Dh ** -0.5)),
            "wo": _w((lambda *s: torch.randn(*s, dtype=torch.bfloat16) * 0.05)(D, D)),
        }
    _A_in = _A_setup()

    def _B_setup():
        B, S, D, H = 1, 2048, 1024, 32
        Dh = D // H
        return {
            "x": _w((lambda *s: torch.randn(*s, dtype=torch.bfloat16) * 0.05)(B, S, D)),
            "wq": _w((lambda *s: torch.randn(*s, dtype=torch.bfloat16) * 0.1)(D, H * Dh)),
            "wk": _w((lambda *s: torch.randn(*s, dtype=torch.bfloat16) * 0.1)(D, Dh)),
            "wv": _w((lambda *s: torch.randn(*s, dtype=torch.bfloat16) * 0.05)(D, Dh)),
            "wo": _w((lambda *s: torch.randn(*s, dtype=torch.bfloat16) * 0.05)(H * Dh, D)),
        }
    _B_in = _B_setup()

    return {
        "A_x": _A_in["x"],
        "A_wqkv": _A_in["wqkv"],
        "A_w_phi": _A_in["w_phi"],
        "A_wo": _A_in["wo"],
        "B_x": _B_in["x"],
        "B_wq": _B_in["wq"],
        "B_wk": _B_in["wk"],
        "B_wv": _B_in["wv"],
        "B_wo": _B_in["wo"],
    }

def reference(A_x, A_wqkv, A_w_phi, A_wo, B_x, B_wq, B_wk, B_wv, B_wo):
    def _A_ref(x, wqkv, w_phi, wo):
        B, S, D = x.shape
        H = 32; Dh = D // H
        qkv = (lambda x, *d: x.permute(*d))((x @ wqkv).reshape(B, S, 3, H, Dh), 2, 0, 3, 1, 4)
        q, k, v = qkv[0], qkv[1], qkv[2]
        pq = torch.einsum("bhsd,hdf->bhsf", q, w_phi)
        pk = torch.einsum("bhsd,hdf->bhsf", k, w_phi)
        phi_q = torch.concatenate([_softmax(pq, axis=-1), _softmax(-pq, axis=-1)], axis=-1)
        phi_k = torch.concatenate([_softmax(pk, axis=-1), _softmax(-pk, axis=-1)], axis=-1)
        kv = torch.einsum("bhsf,bhsd->bhfd", phi_k, v)
        z  = torch.einsum("bhsf->bhf", phi_k)
        num = torch.einsum("bhqf,bhfd->bhqd", phi_q, kv)
        den = torch.einsum("bhqf,bhf->bhq", phi_q, z)[..., None] + 1e-6
        o = num / den
        return (lambda x, *d: x.permute(*d))(o, 0, 2, 1, 3).reshape(B, S, D) @ wo

    def _B_ref(x, wq, wk, wv, wo):
        B, S, D = x.shape
        H = 32
        Dh = D // H
        q = (lambda x, *d: x.permute(*d))((x @ wq).reshape(B, S, H, Dh), 0, 2, 1, 3)
        k = x @ wk
        v = x @ wv
        scores = torch.einsum("bhqd,bkd->bhqk", q, k) * (Dh ** -0.5)
        p = _softmax(scores, axis=-1)
        o = torch.einsum("bhqk,bkd->bhqd", p, v)
        return (lambda x, *d: x.permute(*d))(o, 0, 2, 1, 3).reshape(B, S, H * Dh) @ wo

    x = A_x
    x = x + _A_ref(_layernorm(x, axis=-1), A_wqkv, A_w_phi, A_wo)
    x = x + _B_ref(_layernorm(x, axis=-1), B_wq, B_wk, B_wv, B_wo)
    x = x + _A_ref(_layernorm(x, axis=-1), A_wqkv, A_w_phi, A_wo)
    x = x + _B_ref(_layernorm(x, axis=-1), B_wq, B_wk, B_wv, B_wo)
    return x
```

```asm
; @launch grid=(256,1,1) block=(256,1,1) lds=163840
.amdgcn_target "amdgcn-amd-amdhsa--gfx950"
.text
.globl interleave_layers__linear_kernel_hedgehog__grouped_kv_mqa__prompt_kernel
.p2align 8
.type interleave_layers__linear_kernel_hedgehog__grouped_kv_mqa__prompt_kernel,@function
interleave_layers__linear_kernel_hedgehog__grouped_kv_mqa__prompt_kernel:
    s_cmp_ge_u32 s2, 256
    s_cbranch_scc1 L_end
    s_load_dwordx16 s[64:79], s[0:1], 0
    s_load_dwordx8 s[80:87], s[0:1], 64
    s_getpc_b64 s[88:89]
    v_lshlrev_b32 v232, 7, v0
    global_load_dword v233, v232, s[88:89]
    v_lshrrev_b32 v132, 6, v0
    v_and_b32 v1, 63, v0
    v_readfirstlane_b32 s3, v132
    s_and_b32 s40, s2, 7
    s_lshr_b32 s41, s2, 3
    s_lshr_b32 s90, s40, 2
    s_lshl_b32 s90, s90, 3
    s_lshr_b32 s42, s41, 2
    s_add_u32 s90, s90, s42
    s_and_b32 s91, s40, 3
    s_lshl_b32 s91, s91, 2
    s_and_b32 s42, s41, 3
    s_add_u32 s91, s91, s42
    s_lshr_b32 s92, s40, 1
    s_lshl_b32 s92, s92, 2
    s_lshr_b32 s42, s41, 3
    s_add_u32 s92, s92, s42
    s_and_b32 s93, s40, 1
    s_lshl_b32 s93, s93, 3
    s_and_b32 s42, s41, 7
    s_add_u32 s93, s93, s42
    s_lshr_b32 s94, s40, 1
    s_lshl_b32 s94, s94, 2
    s_lshr_b32 s42, s41, 3
    s_add_u32 s94, s94, s42
    s_and_b32 s95, s40, 1
    s_lshl_b32 s95, s95, 3
    s_and_b32 s42, s41, 7
    s_add_u32 s95, s95, s42
    s_mov_b32 s20, s90
    s_mov_b32 s21, s91
    s_lshl_b32 s22, s20, 2
    s_add_u32 s22, s22, s3
    s_lshl_b32 s23, s22, 16
    s_lshl_b32 s40, s21, 12
    s_add_u32 s23, s23, s40
    s_mov_b32 s6, 268435456
    s_mov_b32 s7, 0x00020000
    s_mov_b32 s11, 0x00020000
    s_mov_b32 s15, 0x00020000
    s_mov_b32 s19, 0x00020000
    v_mov_b32 v27, 0
    v_and_b32 v132, 31, v1
    v_lshrrev_b32 v133, 5, v1
    v_lshlrev_b32 v132, 11, v132
    v_lshl_add_u32 v132, v133, 4, v132
    s_lshl_b32 s40, s22, 16
    s_lshl_b32 s41, s21, 7
    s_add_u32 s43, s40, s41
    s_lshl_b32 s40, s20, 12
    s_lshl_b32 s41, s21, 8
    s_add_u32 s60, s40, s41
    s_add_u32 s60, s60, 31981568
    s_lshl_b32 s40, s21, 12
    s_lshl_b32 s41, s20, 8
    s_add_u32 s61, s40, s41
    s_add_u32 s61, s61, 32047104
    s_lshl_b32 s62, s2, 2
    s_add_u32 s62, s62, s3
    s_lshl_b32 s62, s62, 10
    s_add_u32 s62, s62, 109051904
    s_mov_b32 s18, 4194304
    s_waitcnt lgkmcnt(0)
    s_mov_b32 s16, s64
    s_mov_b32 s17, s65
    s_mov_b32 s4, s86
    s_mov_b32 s5, s87
    s_lshl_b32 s44, s21, 2
    s_add_u32 s44, s44, s3
    s_cmp_lg_u32 s44, 3
    s_cbranch_scc1 L_init0
    v_lshlrev_b32 v133, 8, v1
    v_lshlrev_b32 v134, 12, v1
    v_lshlrev_b32 v135, 2, v1
    s_mov_b64 exec, 0xffff
    s_lshl_b32 s40, s20, 8
    s_add_u32 s40, s40, 32112640
    s_add_u32 s41, s61, 131072
    s_add_u32 s42, s61, 196608
    buffer_store_dword v27, v133, s[4:7], s60 offen sc1
    buffer_store_dword v27, v134, s[4:7], s61 offen sc1
    buffer_store_dword v27, v135, s[4:7], s40 offen sc1
    buffer_store_dword v27, v134, s[4:7], s41 offen sc1
    buffer_store_dword v27, v134, s[4:7], s42 offen sc1
    s_mov_b64 exec, -1
L_init0:
    buffer_load_dwordx4 v[240:243], v132, s[16:19], s43 offen offset:0
    buffer_load_dwordx4 v[244:247], v132, s[16:19], s43 offen offset:32
    buffer_load_dwordx4 v[248:251], v132, s[16:19], s43 offen offset:64
    buffer_load_dwordx4 v[252:255], v132, s[16:19], s43 offen offset:96
    s_mov_b32 s51, s44
L_init1:
    s_lshl_b32 s28, s3, 11
    s_mov_b32 s32, 0x3f803f80
    s_mov_b32 s33, 0
    s_mov_b32 s39, 0
    s_mov_b32 s34, 1
    s_mov_b32 s63, 0
    v_lshlrev_b32 v2, 4, v1
    v_lshlrev_b32 v3, 3, v1
    v_lshlrev_b32 v16, 2, v1
    v_lshlrev_b32 v20, 5, v0
    v_sub_u32 v20, v20, v2
    v_and_b32 v17, 15, v1
    v_lshlrev_b32 v17, 8, v17
    v_lshrrev_b32 v132, 5, v1
    v_bfe_u32 v133, v1, 2, 2
    v_lshl_add_u32 v132, v132, 2, v133
    s_lshl_b32 s40, s3, 4
    v_add_u32 v132, s40, v132
    v_bfe_u32 v133, v1, 4, 1
    v_lshlrev_b32 v133, 6, v133
    v_and_b32 v134, 3, v1
    v_lshl_add_u32 v133, v134, 4, v133
    s_lshl_b32 s40, s21, 7
    s_add_u32 s40, s40, 4096
    v_add_u32 v133, s40, v133
    v_mul_u32_u24 v134, 6144, v132
    v_add_u32 v10, v134, v133
    v_add_u32 v11, 48128, v10
    v_lshl_add_u32 v12, v132, 11, v133
    v_add_u32 v13, 15360, v12
    v_bfe_u32 v132, v1, 2, 2
    v_lshlrev_b32 v132, 6, v132
    v_bfe_u32 v133, v1, 4, 1
    v_lshl_add_u32 v132, v133, 5, v132
    v_and_b32 v133, 3, v1
    v_lshl_add_u32 v132, v133, 3, v132
    v_lshrrev_b32 v133, 5, v1
    v_lshl_add_u32 v26, v133, 8, v132
    v_add_u32 v26, 131072, v26
    v_lshl_add_u32 v14, v133, 9, v132
    v_add_u32 v15, 0x10000, v2
    s_cmp_lg_u32 s3, 0
    s_cbranch_scc1 L_s1_0
    s_sub_u32 s16, s66, 4096
    s_subb_u32 s17, s67, 0
    s_mov_b32 s18, 6295552
    s_mul_i32 s40, s3, 98304
    v_subrev_u32 v136, s40, v10
    v_subrev_u32 v137, s40, v11
    s_mul_i32 s40, s20, 393216
    s_add_u32 s40, s40, 4096
    s_mov_b32 s41, 98304
    s_mov_b32 s42, 33554432
    s_mov_b32 m0, 131072
    s_nop 0
    buffer_load_dwordx4 v136, s[16:19], s40 offen lds
    buffer_load_dwordx4 v137, s[16:19], s40 offen offset:1024 lds
    s_add_u32 s40, s40, s41
    s_mov_b32 m0, 133120
    s_nop 0
    buffer_load_dwordx4 v136, s[16:19], s40 offen lds
    buffer_load_dwordx4 v137, s[16:19], s40 offen offset:1024 lds
    s_add_u32 s40, s40, s41
    s_mov_b32 m0, 135168
    s_nop 0
    buffer_load_dwordx4 v136, s[16:19], s40 offen lds
    buffer_load_dwordx4 v137, s[16:19], s40 offen offset:1024 lds
    s_add_u32 s40, s40, s41
    s_mov_b32 m0, 137216
    s_nop 0
    buffer_load_dwordx4 v136, s[16:19], s40 offen lds
    buffer_load_dwordx4 v137, s[16:19], s40 offen offset:1024 lds
    s_add_u32 s40, s40, s41
    s_branch L_s1d
L_s1_0:
    s_cmp_lg_u32 s3, 1
    s_cbranch_scc1 L_s1_1
    s_sub_u32 s16, s66, 4096
    s_subb_u32 s17, s67, 0
    s_mov_b32 s18, 6295552
    s_mul_i32 s40, s3, 98304
    v_subrev_u32 v136, s40, v10
    v_subrev_u32 v137, s40, v11
    s_mul_i32 s40, s20, 393216
    s_add_u32 s40, s40, 2048
    s_mov_b32 s41, 98304
    s_mov_b32 s42, 35651584
    s_mov_b32 m0, 139264
    s_nop 0
    buffer_load_dwordx4 v136, s[16:19], s40 offen lds
    buffer_load_dwordx4 v137, s[16:19], s40 offen offset:1024 lds
    s_add_u32 s40, s40, s41
    s_mov_b32 m0, 141312
    s_nop 0
    buffer_load_dwordx4 v136, s[16:19], s40 offen lds
    buffer_load_dwordx4 v137, s[16:19], s40 offen offset:1024 lds
    s_add_u32 s40, s40, s41
    s_mov_b32 m0, 143360
    s_nop 0
    buffer_load_dwordx4 v136, s[16:19], s40 offen lds
    buffer_load_dwordx4 v137, s[16:19], s40 offen offset:1024 lds
    s_add_u32 s40, s40, s41
    s_mov_b32 m0, 145408
    s_nop 0
    buffer_load_dwordx4 v136, s[16:19], s40 offen lds
    buffer_load_dwordx4 v137, s[16:19], s40 offen offset:1024 lds
    s_add_u32 s40, s40, s41
    s_branch L_s1d
L_s1_1:
    s_cmp_lg_u32 s3, 2
    s_cbranch_scc1 L_s1_2
    s_sub_u32 s16, s66, 4096
    s_subb_u32 s17, s67, 0
    s_mov_b32 s18, 6295552
    s_mul_i32 s40, s3, 98304
    v_subrev_u32 v136, s40, v10
    v_subrev_u32 v137, s40, v11
    s_mul_i32 s40, s20, 393216
    s_add_u32 s40, s40, 0
    s_mov_b32 s41, 98304
    s_mov_b32 s42, 37748736
    s_mov_b32 m0, 147456
    s_nop 0
    buffer_load_dwordx4 v136, s[16:19], s40 offen lds
    buffer_load_dwordx4 v137, s[16:19], s40 offen offset:1024 lds
    s_add_u32 s40, s40, s41
    s_mov_b32 m0, 149504
    s_nop 0
    buffer_load_dwordx4 v136, s[16:19], s40 offen lds
    buffer_load_dwordx4 v137, s[16:19], s40 offen offset:1024 lds
    s_add_u32 s40, s40, s41
    s_mov_b32 m0, 151552
    s_nop 0
    buffer_load_dwordx4 v136, s[16:19], s40 offen lds
    buffer_load_dwordx4 v137, s[16:19], s40 offen offset:1024 lds
    s_add_u32 s40, s40, s41
    s_mov_b32 m0, 153600
    s_nop 0
    buffer_load_dwordx4 v136, s[16:19], s40 offen lds
    buffer_load_dwordx4 v137, s[16:19], s40 offen offset:1024 lds
    s_add_u32 s40, s40, s41
    s_branch L_s1d
L_s1_2:
    s_sub_u32 s16, s74, 4096
    s_subb_u32 s17, s75, 0
    s_mov_b32 s18, 2101248
    s_mul_i32 s40, s3, 32768
    v_subrev_u32 v136, s40, v12
    v_subrev_u32 v137, s40, v13
    s_mul_i32 s40, s20, 131072
    s_add_u32 s40, s40, 0
    s_mov_b32 s41, 32768
    s_mov_b32 s42, 39845888
    s_mov_b32 m0, 155648
    s_nop 0
    buffer_load_dwordx4 v136, s[16:19], s40 offen lds
    buffer_load_dwordx4 v137, s[16:19], s40 offen offset:1024 lds
    s_add_u32 s40, s40, s41
    s_mov_b32 m0, 157696
    s_nop 0
    buffer_load_dwordx4 v136, s[16:19], s40 offen lds
    buffer_load_dwordx4 v137, s[16:19], s40 offen offset:1024 lds
    s_add_u32 s40, s40, s41
    s_mov_b32 m0, 159744
    s_nop 0
    buffer_load_dwordx4 v136, s[16:19], s40 offen lds
    buffer_load_dwordx4 v137, s[16:19], s40 offen offset:1024 lds
    s_add_u32 s40, s40, s41
    s_mov_b32 m0, 161792
    s_nop 0
    buffer_load_dwordx4 v136, s[16:19], s40 offen lds
    buffer_load_dwordx4 v137, s[16:19], s40 offen offset:1024 lds
    s_add_u32 s40, s40, s41
L_s1d:
    v_bfe_u32 v132, v1, 2, 1
    v_bfe_u32 v133, v1, 4, 1
    v_cmp_eq_u32 vcc, v132, v133
    v_lshrrev_b32 v132, 5, v1
    v_lshlrev_b32 v132, 7, v132
    v_and_b32 v133, 3, v1
    v_lshl_add_u32 v132, v133, 4, v132
    v_bfe_u32 v133, v1, 3, 1
    v_lshl_add_u32 v132, v133, 6, v132
    v_mov_b32 v133, 256
    v_cndmask_b32 v132, v133, v132, vcc
    v_add_u32 v19, 135168, v132
    s_mov_b32 s16, s84
    s_mov_b32 s17, s85
    s_mov_b32 s18, 256
    s_waitcnt vmcnt(8)
    s_cmp_lg_u32 s51, 3
    s_cbranch_scc1 L_init2
    v_mov_b32 v133, 1
    s_mov_b64 exec, 1
    buffer_store_byte v133, v27, s[16:19], s20 offen sc1
    s_mov_b64 exec, -1
L_init2:
    v_permlane32_swap_b32 v240, v242
    v_permlane32_swap_b32 v241, v243
    v_permlane32_swap_b32 v244, v246
    v_permlane32_swap_b32 v245, v247
    v_permlane32_swap_b32 v248, v250
    v_permlane32_swap_b32 v249, v251
    v_permlane32_swap_b32 v252, v254
    v_permlane32_swap_b32 v253, v255
    s_add_u32 s44, s33, 0
    s_add_u32 s45, s33, 21233664
    s_call_b64 s[30:31], L_xout
    s_lshl_b32 s44, s3, 13
    s_add_u32 s44, s44, 131072
    s_lshl_b32 s37, s3, 21
    s_add_u32 s37, s37, 33554432
    s_waitcnt vmcnt(5)
    s_call_b64 s[30:31], L_blk4
    s_mov_b32 s16, s84
    s_mov_b32 s17, s85
    s_mov_b32 s18, 256
    s_cmp_lg_u32 s3, 0
    s_cbranch_scc1 L_init4
    s_mov_b32 s35, 0
    s_mov_b32 s40, 0x01010101
    v_and_b32 v132, 12, v16
L_init3:
    buffer_load_dword v133, v132, s[16:19], 0 offen sc1
    s_add_u32 s35, s35, 1
    s_waitcnt vmcnt(0)
    v_cmp_eq_u32 vcc, s40, v133
    s_nop 0
    s_cmp_eq_u64 vcc, exec
    s_cbranch_scc1 L_init4
    s_sleep 1
    s_cmp_lt_u32 s35, 0x40000
    s_cbranch_scc1 L_init3
    s_endpgm
L_init4:
    s_waitcnt vmcnt(0)
    s_barrier
    s_cmp_lg_u32 s3, 0
    s_cbranch_scc1 L_pub1
    v_mov_b32 v4, s34
    s_mov_b64 exec, 1
    buffer_store_dword v4, v27, s[4:7], s60 offen sc1
    s_mov_b64 exec, -1
L_pub1:
    s_cmp_lg_u32 s3, 0
    s_cbranch_scc1 L_pub2
    v_mov_b32 v4, s34
    s_mov_b64 exec, 1
    buffer_store_dword v4, v27, s[4:7], s61 offen sc1
    s_mov_b64 exec, -1
L_pub2:
    s_cmp_lg_u32 s3, 0
    s_cbranch_scc1 L_s2_0
    s_sub_u32 s16, s70, 4096
    s_subb_u32 s17, s71, 0
    s_mov_b32 s18, 2101248
    s_mul_i32 s40, s3, 32768
    v_subrev_u32 v136, s40, v12
    v_subrev_u32 v137, s40, v13
    s_mul_i32 s40, s20, 131072
    s_add_u32 s40, s40, 0
    s_mov_b32 s41, 32768
    s_mov_b32 s42, 41943040
    s_mov_b32 m0, 131072
    s_nop 0
    buffer_load_dwordx4 v136, s[16:19], s40 offen lds
    buffer_load_dwordx4 v137, s[16:19], s40 offen offset:1024 lds
    s_add_u32 s40, s40, s41
    s_mov_b32 m0, 133120
    s_nop 0
    buffer_load_dwordx4 v136, s[16:19], s40 offen lds
    buffer_load_dwordx4 v137, s[16:19], s40 offen offset:1024 lds
    s_add_u32 s40, s40, s41
    s_mov_b32 s38, 41943040
    s_branch L_s2d
L_s2_0:
    s_cmp_lg_u32 s3, 1
    s_cbranch_scc1 L_s2_1
    s_sub_u32 s16, s70, 4096
    s_subb_u32 s17, s71, 0
    s_mov_b32 s18, 2101248
    s_mul_i32 s40, s3, 32768
    v_subrev_u32 v136, s40, v12
    v_subrev_u32 v137, s40, v13
    s_mul_i32 s40, s20, 131072
    s_add_u32 s40, s40, 0
    s_mov_b32 s41, 32768
    s_mov_b32 s42, 41943040
    s_add_u32 s40, s40, 65536
    s_mov_b32 m0, 139264
    s_nop 0
    buffer_load_dwordx4 v136, s[16:19], s40 offen lds
    buffer_load_dwordx4 v137, s[16:19], s40 offen offset:1024 lds
    s_add_u32 s40, s40, s41
    s_mov_b32 m0, 141312
    s_nop 0
    buffer_load_dwordx4 v136, s[16:19], s40 offen lds
    buffer_load_dwordx4 v137, s[16:19], s40 offen offset:1024 lds
    s_add_u32 s40, s40, s41
    s_mov_b32 s38, 41947136
    s_branch L_s2d
L_s2_1:
    s_cmp_lg_u32 s3, 2
    s_cbranch_scc1 L_s2_2
    s_sub_u32 s16, s80, 4096
    s_subb_u32 s17, s81, 0
    s_mov_b32 s18, 2101248
    s_mul_i32 s40, s3, 32768
    v_subrev_u32 v136, s40, v12
    v_subrev_u32 v137, s40, v13
    s_mul_i32 s40, s20, 131072
    s_add_u32 s40, s40, 0
    s_mov_b32 s41, 32768
    s_mov_b32 s42, 44040192
    s_mov_b32 m0, 147456
    s_nop 0
    buffer_load_dwordx4 v136, s[16:19], s40 offen lds
    buffer_load_dwordx4 v137, s[16:19], s40 offen offset:1024 lds
    s_add_u32 s40, s40, s41
    s_mov_b32 m0, 149504
    s_nop 0
    buffer_load_dwordx4 v136, s[16:19], s40 offen lds
    buffer_load_dwordx4 v137, s[16:19], s40 offen offset:1024 lds
    s_add_u32 s40, s40, s41
    s_mov_b32 s38, 44040192
    s_branch L_s2d
L_s2_2:
    s_sub_u32 s16, s80, 4096
    s_subb_u32 s17, s81, 0
    s_mov_b32 s18, 2101248
    s_mul_i32 s40, s3, 32768
    v_subrev_u32 v136, s40, v12
    v_subrev_u32 v137, s40, v13
    s_mul_i32 s40, s20, 131072
    s_add_u32 s40, s40, 0
    s_mov_b32 s41, 32768
    s_mov_b32 s42, 44040192
    s_add_u32 s40, s40, 65536
    s_mov_b32 m0, 155648
    s_nop 0
    buffer_load_dwordx4 v136, s[16:19], s40 offen lds
    buffer_load_dwordx4 v137, s[16:19], s40 offen offset:1024 lds
    s_add_u32 s40, s40, s41
    s_mov_b32 m0, 157696
    s_nop 0
    buffer_load_dwordx4 v136, s[16:19], s40 offen lds
    buffer_load_dwordx4 v137, s[16:19], s40 offen offset:1024 lds
    s_add_u32 s40, s40, s41
    s_mov_b32 s38, 44044288
L_s2d:
    s_cmp_ge_u32 s21, 4
    s_cselect_b32 s16, s78, s76
    s_cselect_b32 s17, s79, s77
    s_mov_b32 s18, 65536
    s_and_b32 s40, s21, 3
    s_lshl_b32 s40, s40, 4
    s_add_u32 s41, s40, 8
    s_cmp_ge_u32 s21, 4
    s_cbranch_scc1 L_mt1
    s_lshr_b32 s40, s21, 1
    s_lshl_b32 s40, s40, 5
    s_and_b32 s41, s21, 1
    s_lshl_b32 s41, s41, 3
    s_add_u32 s40, s40, s41
    s_add_u32 s41, s40, 16
L_mt1:
    v_lshlrev_b32 v132, 8, v1
    s_lshl_b32 s42, s20, 12
    s_add_u32 s40, s40, s42
    s_add_u32 s41, s41, s42
    s_mov_b64 exec, 0xffff
    buffer_load_dwordx2 v[220:221], v132, s[16:19], s40 offen offset:0
    buffer_load_dwordx2 v[222:223], v132, s[16:19], s40 offen offset:64
    buffer_load_dwordx2 v[224:225], v132, s[16:19], s40 offen offset:128
    buffer_load_dwordx2 v[226:227], v132, s[16:19], s40 offen offset:192
    buffer_load_dwordx2 v[228:229], v132, s[16:19], s41 offen offset:0
    buffer_load_dwordx2 v[230:231], v132, s[16:19], s41 offen offset:64
    buffer_load_dwordx2 v[232:233], v132, s[16:19], s41 offen offset:128
    buffer_load_dwordx2 v[234:235], v132, s[16:19], s41 offen offset:192
    s_mov_b64 exec, -1
    s_lshl_b32 s44, s3, 13
    s_add_u32 s44, s44, 131072
    s_waitcnt vmcnt(0)
    s_call_b64 s[30:31], L_blk2
    s_cmp_lg_u32 s3, 0
    s_cbranch_scc1 L_sw_d
    s_and_b32 s40, s60, 0xfffff0ff
    s_and_b32 s41, s61, 0xfffff0ff
    s_lshl_b32 s42, s95, 12
    s_add_u32 s42, s42, 32047104
    v_mov_b32 v132, s40
    v_mov_b32 v133, s41
    v_lshrrev_b32 v134, 4, v1
    v_cmp_eq_u32 vcc, 1, v134
    s_nop 1
    v_cndmask_b32 v132, v132, v133, vcc
    v_mov_b32 v133, s42
    v_cmp_eq_u32 vcc, 2, v134
    s_nop 1
    v_cndmask_b32 v132, v132, v133, vcc
    v_add_u32 v132, v132, v17
    s_mov_b32 s35, 0
L_sw_l:
    buffer_load_dword v133, v132, s[4:7], 0 offen sc1
    s_add_u32 s35, s35, 1
    s_waitcnt vmcnt(0)
    v_cmp_le_u32 vcc, s34, v133
    s_nop 0
    s_cmp_eq_u64 vcc, exec
    s_cbranch_scc1 L_sw_d
    s_sleep 1
    s_cmp_lt_u32 s35, 0x40000
    s_cbranch_scc1 L_sw_l
    s_endpgm
L_sw_d:
    s_waitcnt vmcnt(0)
    s_barrier
    s_add_u32 s46, s61, 196608
    s_cmp_lg_u32 s3, 0
    s_cbranch_scc1 L_pub3
    v_mov_b32 v4, s34
    s_mov_b64 exec, 1
    buffer_store_dword v4, v27, s[4:7], s46 offen sc1
    s_mov_b64 exec, -1
L_pub3:
    s_add_u32 s34, s34, 1
    s_cmp_eq_u32 s3, 3
    s_cselect_b32 s40, s95, s21
    s_lshl_b32 s40, s40, 2
    s_add_u32 s40, s40, s3
    s_lshl_b32 s40, s40, 12
    s_add_u32 s40, s40, 31522816
    buffer_load_dword v136, v16, s[4:7], s40 offen offset:0 sc1
    buffer_load_dword v137, v16, s[4:7], s40 offen offset:256 sc1
    buffer_load_dword v138, v16, s[4:7], s40 offen offset:512 sc1
    buffer_load_dword v139, v16, s[4:7], s40 offen offset:768 sc1
    buffer_load_dword v140, v16, s[4:7], s40 offen offset:1024 sc1
    buffer_load_dword v141, v16, s[4:7], s40 offen offset:1280 sc1
    buffer_load_dword v142, v16, s[4:7], s40 offen offset:1536 sc1
    buffer_load_dword v143, v16, s[4:7], s40 offen offset:1792 sc1
    buffer_load_dword v144, v16, s[4:7], s40 offen offset:2048 sc1
    buffer_load_dword v145, v16, s[4:7], s40 offen offset:2304 sc1
    buffer_load_dword v146, v16, s[4:7], s40 offen offset:2560 sc1
    buffer_load_dword v147, v16, s[4:7], s40 offen offset:2816 sc1
    buffer_load_dword v148, v16, s[4:7], s40 offen offset:3072 sc1
    buffer_load_dword v149, v16, s[4:7], s40 offen offset:3328 sc1
    buffer_load_dword v150, v16, s[4:7], s40 offen offset:3584 sc1
    buffer_load_dword v151, v16, s[4:7], s40 offen offset:3840 sc1
    s_mov_b32 s16, s68
    s_mov_b32 s17, s69
    s_mov_b32 s18, 65536
    s_lshl_b32 s40, s21, 12
    s_lshl_b32 s41, s3, 10
    s_add_u32 s40, s40, s41
    s_add_u32 m0, s41, 131072
    s_nop 0
    buffer_load_dwordx4 v2, s[16:19], s40 offen lds
    s_mov_b32 s8, s86
    s_mov_b32 s9, s87
    s_mov_b32 s10, 268435456
    s_lshl_b32 s24, s91, 17
    s_add_u32 s24, s24, 35651584
    s_mov_b32 s25, 8192
    v_mov_b32 v6, v20
    v_mov_b32 v7, v20
    s_mov_b32 s52, 0
    s_call_b64 s[30:31], L_grp2
    s_mov_b32 s52, 65536
    s_call_b64 s[30:31], L_grp2
    s_waitcnt vmcnt(32)
    s_lshl_b32 s40, s3, 9
    s_add_u32 s40, s40, 153600
    v_add_u32 v132, s40, v3
    v_pk_add_f32 v[136:137], v[136:137], v[144:145]
    v_pk_add_f32 v[138:139], v[138:139], v[146:147]
    v_pk_add_f32 v[140:141], v[140:141], v[148:149]
    v_pk_add_f32 v[142:143], v[142:143], v[150:151]
    v_pk_add_f32 v[136:137], v[136:137], v[140:141]
    v_pk_add_f32 v[138:139], v[138:139], v[142:143]
    v_pk_add_f32 v[136:137], v[136:137], v[138:139]
    v_add_f32 v136, v136, v137
    v_and_b32 v137, 0xffff0000, v136
    v_sub_f32 v136, v136, v137
    v_cvt_pk_bf16_f32 v138, v137, v136
    v_cvt_pk_bf16_f32 v139, v137, 0
    ds_write_b64 v132, v[138:139]
    s_waitcnt lgkmcnt(0)
L_pair:
    s_lshl_b32 s40, s22, 12
    s_add_u32 s40, s40, s33
    s_add_u32 s40, s40, 21233664
    v_and_b32 v4, 31, v1
    v_lshrrev_b32 v5, 5, v1
    v_lshlrev_b32 v4, 3, v4
    v_lshl_add_u32 v4, v5, 11, v4
    buffer_load_dwordx2 v[116:117], v4, s[4:7], s40 offen offset:0 sc1
    buffer_load_dwordx2 v[118:119], v4, s[4:7], s40 offen offset:256 sc1
    buffer_load_dwordx2 v[120:121], v4, s[4:7], s40 offen offset:512 sc1
    buffer_load_dwordx2 v[122:123], v4, s[4:7], s40 offen offset:768 sc1
    buffer_load_dwordx2 v[124:125], v4, s[4:7], s40 offen offset:1024 sc1
    buffer_load_dwordx2 v[126:127], v4, s[4:7], s40 offen offset:1280 sc1
    buffer_load_dwordx2 v[128:129], v4, s[4:7], s40 offen offset:1536 sc1
    buffer_load_dwordx2 v[130:131], v4, s[4:7], s40 offen offset:1792 sc1
    s_lshl_b32 s36, s22, 16
    s_add_u32 s36, s36, s33
    s_add_u32 s36, s36, 0
    s_call_b64 s[30:31], L_x0
    s_mov_b32 s12, s86
    s_mov_b32 s13, s87
    s_mov_b32 s14, 268435456
    s_lshl_b32 s26, s91, 17
    s_add_u32 s26, s26, 33554432
    s_mov_b32 s27, 8192
    v_mov_b32 v8, v20
    v_mov_b32 v9, v20
    s_waitcnt vmcnt(8)
    s_call_b64 s[30:31], L_stats
    s_mov_b64 vcc, 1
    s_call_b64 s[30:31], L_passF
L_after_k:
    s_mov_b32 s8, s12
    s_mov_b32 s9, s13
    s_mov_b32 s10, s14
    s_mov_b32 s24, s26
    s_mov_b32 s25, s27
    v_mov_b32 v6, v8
    v_mov_b32 v7, v9
    s_mov_b32 s12, s86
    s_mov_b32 s13, s87
    s_mov_b32 s14, 268435456
    s_lshl_b32 s26, s91, 17
    s_add_u32 s26, s26, 37748736
    s_mov_b32 s27, 8192
    v_mov_b32 v8, v20
    v_mov_b32 v9, v20
    s_mov_b32 s53, 154112
    v_mul_f32 v134, 0x3fb8aa3b, v30
    s_call_b64 s[30:31], L_ln
    ds_read_b64_tr_b16 v[132:133], v26 offset:0
    ds_read_b64_tr_b16 v[134:135], v26 offset:512
    ds_read_b64_tr_b16 v[136:137], v26 offset:1024
    ds_read_b64_tr_b16 v[138:139], v26 offset:1536
    ds_read_b64_tr_b16 v[140:141], v26 offset:2048
    ds_read_b64_tr_b16 v[142:143], v26 offset:2560
    ds_read_b64_tr_b16 v[144:145], v26 offset:3072
    ds_read_b64_tr_b16 v[146:147], v26 offset:3584
    s_waitcnt lgkmcnt(0)
    s_call_b64 s[30:31], L_passV
    s_mov_b32 s8, s12
    s_mov_b32 s9, s13
    s_mov_b32 s10, s14
    s_mov_b32 s24, s26
    s_mov_b32 s25, s27
    v_mov_b32 v6, v8
    v_mov_b32 v7, v9
    s_mov_b32 s12, s86
    s_mov_b32 s13, s87
    s_mov_b32 s14, 268435456
    s_lshl_b32 s26, s93, 17
    s_add_u32 s26, s26, 41943040
    s_mov_b32 s27, 8192
    v_mov_b32 v8, v20
    v_mov_b32 v9, v20
    s_add_u32 s56, s39, s3
    s_cmp_lg_u32 s56, 0
    s_cbranch_scc1 L_im_d
    v_mov_b32 v132, s93
    v_mov_b32 v133, s95
    v_cmp_gt_u32 vcc, 32, v1
    s_nop 1
    v_cndmask_b32 v132, v132, v133, vcc
    v_lshl_add_u32 v132, v132, 12, v17
    s_mov_b32 s56, 32243712
    s_mov_b32 s35, 0
L_im_l:
    buffer_load_dword v133, v132, s[4:7], s56 offen sc1
    s_add_u32 s35, s35, 1
    s_waitcnt vmcnt(0)
    v_cmp_le_u32 vcc, 1, v133
    s_nop 0
    s_cmp_eq_u64 vcc, exec
    s_cbranch_scc1 L_im_d
    s_sleep 1
    s_cmp_lt_u32 s35, 0x40000
    s_cbranch_scc1 L_im_l
    s_endpgm
L_im_d:
    s_barrier
    ds_write_b64 v104, v[204:205] offset:0
    ds_write_b64 v105, v[206:207] offset:0
    ds_write_b64 v106, v[208:209] offset:0
    ds_write_b64 v107, v[210:211] offset:0
    ds_write_b64 v108, v[212:213] offset:0
    ds_write_b64 v109, v[214:215] offset:0
    ds_write_b64 v110, v[216:217] offset:0
    ds_write_b64 v111, v[218:219] offset:0
    ds_write_b64 v104, v[220:221] offset:16384
    ds_write_b64 v105, v[222:223] offset:16384
    ds_write_b64 v106, v[224:225] offset:16384
    ds_write_b64 v107, v[226:227] offset:16384
    ds_write_b64 v108, v[228:229] offset:16384
    ds_write_b64 v109, v[230:231] offset:16384
    ds_write_b64 v110, v[232:233] offset:16384
    ds_write_b64 v111, v[234:235] offset:16384
    s_mov_b32 s53, 153600
    v_mul_f32 v134, 0x3f800000, v30
    s_call_b64 s[30:31], L_ln
    ds_write_b64 v104, v[116:117] offset:32768
    ds_write_b64 v105, v[118:119] offset:32768
    ds_write_b64 v106, v[120:121] offset:32768
    ds_write_b64 v107, v[122:123] offset:32768
    ds_write_b64 v108, v[124:125] offset:32768
    ds_write_b64 v109, v[126:127] offset:32768
    ds_write_b64 v110, v[128:129] offset:32768
    ds_write_b64 v111, v[130:131] offset:32768
    s_waitcnt lgkmcnt(0)
    s_barrier
    ds_read_b64_tr_b16 v[152:153], v112 offset:0
    ds_read_b64_tr_b16 v[154:155], v113 offset:1024
    ds_read_b64_tr_b16 v[184:185], v114 offset:0
    ds_read_b64_tr_b16 v[186:187], v115 offset:1024
    ds_read_b64_tr_b16 v[156:157], v112 offset:2048
    ds_read_b64_tr_b16 v[158:159], v113 offset:3072
    ds_read_b64_tr_b16 v[188:189], v114 offset:2048
    ds_read_b64_tr_b16 v[190:191], v115 offset:3072
    ds_read_b64_tr_b16 v[160:161], v112 offset:4096
    ds_read_b64_tr_b16 v[162:163], v113 offset:5120
    ds_read_b64_tr_b16 v[192:193], v114 offset:4096
    ds_read_b64_tr_b16 v[194:195], v115 offset:5120
    s_waitcnt lgkmcnt(8)
    ds_read_b64_tr_b16 v[164:165], v112 offset:6144
    ds_read_b64_tr_b16 v[166:167], v113 offset:7168
    ds_read_b64_tr_b16 v[196:197], v114 offset:6144
    ds_read_b64_tr_b16 v[198:199], v115 offset:7168
    v_mfma_f32_32x32x16_bf16 v[32:47], v[152:155], v[184:187], 0
    v_mfma_f32_16x16x32_bf16 v[48:51], v[100:103], v[152:155], 0
    s_waitcnt lgkmcnt(8)
    ds_read_b64_tr_b16 v[168:169], v112 offset:8192
    ds_read_b64_tr_b16 v[170:171], v113 offset:9216
    ds_read_b64_tr_b16 v[200:201], v114 offset:8192
    ds_read_b64_tr_b16 v[202:203], v115 offset:9216
    v_mfma_f32_32x32x16_bf16 v[32:47], v[156:159], v[188:191], v[32:47]
    v_mfma_f32_16x16x32_bf16 v[48:51], v[100:103], v[156:159], v[48:51]
    s_waitcnt lgkmcnt(8)
    ds_read_b64_tr_b16 v[172:173], v112 offset:10240
    ds_read_b64_tr_b16 v[174:175], v113 offset:11264
    ds_read_b64_tr_b16 v[204:205], v114 offset:10240
    ds_read_b64_tr_b16 v[206:207], v115 offset:11264
    v_mfma_f32_32x32x16_bf16 v[32:47], v[160:163], v[192:195], v[32:47]
    v_mfma_f32_16x16x32_bf16 v[48:51], v[100:103], v[160:163], v[48:51]
    s_waitcnt lgkmcnt(8)
    ds_read_b64_tr_b16 v[176:177], v112 offset:12288
    ds_read_b64_tr_b16 v[178:179], v113 offset:13312
    ds_read_b64_tr_b16 v[208:209], v114 offset:12288
    ds_read_b64_tr_b16 v[210:211], v115 offset:13312
    v_mfma_f32_32x32x16_bf16 v[32:47], v[164:167], v[196:199], v[32:47]
    v_mfma_f32_16x16x32_bf16 v[48:51], v[100:103], v[164:167], v[48:51]
    s_waitcnt lgkmcnt(8)
    ds_read_b64_tr_b16 v[180:181], v112 offset:14336
    ds_read_b64_tr_b16 v[182:183], v113 offset:15360
    ds_read_b64_tr_b16 v[212:213], v114 offset:14336
    ds_read_b64_tr_b16 v[214:215], v115 offset:15360
    v_mfma_f32_32x32x16_bf16 v[32:47], v[168:171], v[200:203], v[32:47]
    v_mfma_f32_16x16x32_bf16 v[48:51], v[100:103], v[168:171], v[48:51]
    s_waitcnt lgkmcnt(8)
    v_mfma_f32_32x32x16_bf16 v[32:47], v[172:175], v[204:207], v[32:47]
    v_mfma_f32_16x16x32_bf16 v[48:51], v[100:103], v[172:175], v[48:51]
    s_waitcnt lgkmcnt(4)
    v_mfma_f32_32x32x16_bf16 v[32:47], v[176:179], v[208:211], v[32:47]
    v_mfma_f32_16x16x32_bf16 v[48:51], v[100:103], v[176:179], v[48:51]
    s_waitcnt lgkmcnt(0)
    v_mfma_f32_32x32x16_bf16 v[32:47], v[180:183], v[212:215], v[32:47]
    v_mfma_f32_16x16x32_bf16 v[48:51], v[100:103], v[180:183], v[48:51]
    s_nop 10
    buffer_store_dwordx4 v[32:35], v2, s[4:7], s41 offen offset:0 sc1
    buffer_store_dwordx4 v[36:39], v2, s[4:7], s41 offen offset:1024 sc1
    buffer_store_dwordx4 v[40:43], v2, s[4:7], s41 offen offset:2048 sc1
    buffer_store_dwordx4 v[44:47], v2, s[4:7], s41 offen offset:3072 sc1
    v_mul_f32 v48, 0.5, v48
    buffer_store_dword v48, v16, s[4:7], s42 offen sc1
    s_cmp_eq_u32 s3, 0
    s_cselect_b32 s63, 1, 0
    s_and_b32 s29, s61, 0xfffff0ff
    s_call_b64 s[30:31], L_passR
    s_mov_b32 s63, 0
    s_add_u32 s46, s61, 131072
    s_cmp_lg_u32 s3, 0
    s_cbranch_scc1 L_qa0
    s_waitcnt vmcnt(0)
L_qa0:
    s_cmp_lg_u32 s3, 0
    s_cbranch_scc1 L_pub4
    v_mov_b32 v4, s34
    s_mov_b64 exec, 1
    buffer_store_dword v4, v27, s[4:7], s46 offen sc1
    s_mov_b64 exec, -1
L_pub4:
    s_mov_b32 s8, s12
    s_mov_b32 s9, s13
    s_mov_b32 s10, s14
    s_mov_b32 s24, s26
    s_mov_b32 s25, s27
    v_mov_b32 v6, v8
    v_mov_b32 v7, v9
    s_mov_b32 s53, 154624
    v_mul_f32 v134, 0x3fb8aa3b, v30
    s_call_b64 s[30:31], L_ln
    ds_read_b64_tr_b16 v[132:133], v26 offset:0
    ds_read_b64_tr_b16 v[134:135], v26 offset:512
    ds_read_b64_tr_b16 v[136:137], v26 offset:1024
    ds_read_b64_tr_b16 v[138:139], v26 offset:1536
    ds_read_b64_tr_b16 v[140:141], v26 offset:2048
    ds_read_b64_tr_b16 v[142:143], v26 offset:2560
    ds_read_b64_tr_b16 v[144:145], v26 offset:3072
    ds_read_b64_tr_b16 v[146:147], v26 offset:3584
    s_waitcnt lgkmcnt(0)
    v_mfma_f32_32x32x16_bf16 v[148:163], v[132:135], v[116:119], 0
    v_mfma_f32_32x32x16_bf16 v[148:163], v[136:139], v[120:123], v[148:163]
    v_mfma_f32_32x32x16_bf16 v[164:179], v[140:143], v[124:127], 0
    v_mfma_f32_32x32x16_bf16 v[164:179], v[144:147], v[128:131], v[164:179]
    s_and_b32 s56, s46, 0xfffff0ff
    s_nop 8
    v_max3_f32 v196, v148, v149, v150
    v_min3_f32 v198, v148, v149, v150
    v_max3_f32 v196, v196, v151, v152
    v_min3_f32 v198, v198, v151, v152
    v_max3_f32 v196, v196, v153, v154
    v_min3_f32 v198, v198, v153, v154
    v_max3_f32 v196, v196, v155, v156
    v_min3_f32 v198, v198, v155, v156
    v_max3_f32 v196, v196, v157, v158
    v_min3_f32 v198, v198, v157, v158
    v_max3_f32 v196, v196, v159, v160
    v_min3_f32 v198, v198, v159, v160
    v_max3_f32 v196, v196, v161, v162
    v_min3_f32 v198, v198, v161, v162
    v_max_f32 v196, v196, v163
    v_min_f32 v198, v198, v163
    v_mov_b32 v200, v196
    v_mov_b32 v201, v198
    s_nop 0
    v_permlane32_swap_b32 v200, v196
    v_permlane32_swap_b32 v201, v198
    v_max_f32 v196, v200, v196
    v_min_f32 v198, v201, v198
    v_pk_add_f32 v[180:181], v[198:199], v[148:149] op_sel_hi:[0,1] neg_lo:[0,1] neg_hi:[0,1]
    v_pk_add_f32 v[148:149], v[148:149], v[196:197] op_sel_hi:[1,0] neg_lo:[0,1] neg_hi:[0,1]
    v_pk_add_f32 v[182:183], v[198:199], v[150:151] op_sel_hi:[0,1] neg_lo:[0,1] neg_hi:[0,1]
    v_pk_add_f32 v[150:151], v[150:151], v[196:197] op_sel_hi:[1,0] neg_lo:[0,1] neg_hi:[0,1]
    v_pk_add_f32 v[184:185], v[198:199], v[152:153] op_sel_hi:[0,1] neg_lo:[0,1] neg_hi:[0,1]
    v_pk_add_f32 v[152:153], v[152:153], v[196:197] op_sel_hi:[1,0] neg_lo:[0,1] neg_hi:[0,1]
    v_pk_add_f32 v[186:187], v[198:199], v[154:155] op_sel_hi:[0,1] neg_lo:[0,1] neg_hi:[0,1]
    v_pk_add_f32 v[154:155], v[154:155], v[196:197] op_sel_hi:[1,0] neg_lo:[0,1] neg_hi:[0,1]
    v_pk_add_f32 v[188:189], v[198:199], v[156:157] op_sel_hi:[0,1] neg_lo:[0,1] neg_hi:[0,1]
    v_pk_add_f32 v[156:157], v[156:157], v[196:197] op_sel_hi:[1,0] neg_lo:[0,1] neg_hi:[0,1]
    v_pk_add_f32 v[190:191], v[198:199], v[158:159] op_sel_hi:[0,1] neg_lo:[0,1] neg_hi:[0,1]
    v_pk_add_f32 v[158:159], v[158:159], v[196:197] op_sel_hi:[1,0] neg_lo:[0,1] neg_hi:[0,1]
    v_pk_add_f32 v[192:193], v[198:199], v[160:161] op_sel_hi:[0,1] neg_lo:[0,1] neg_hi:[0,1]
    v_pk_add_f32 v[160:161], v[160:161], v[196:197] op_sel_hi:[1,0] neg_lo:[0,1] neg_hi:[0,1]
    v_pk_add_f32 v[194:195], v[198:199], v[162:163] op_sel_hi:[0,1] neg_lo:[0,1] neg_hi:[0,1]
    v_pk_add_f32 v[162:163], v[162:163], v[196:197] op_sel_hi:[1,0] neg_lo:[0,1] neg_hi:[0,1]
    v_exp_f32 v148, v148
    v_exp_f32 v180, v180
    v_exp_f32 v149, v149
    v_exp_f32 v181, v181
    v_exp_f32 v150, v150
    v_exp_f32 v182, v182
    v_exp_f32 v151, v151
    v_exp_f32 v183, v183
    v_exp_f32 v152, v152
    v_exp_f32 v184, v184
    v_exp_f32 v153, v153
    v_exp_f32 v185, v185
    v_exp_f32 v154, v154
    v_exp_f32 v186, v186
    v_exp_f32 v155, v155
    v_exp_f32 v187, v187
    v_exp_f32 v156, v156
    v_exp_f32 v188, v188
    v_exp_f32 v157, v157
    v_exp_f32 v189, v189
    v_exp_f32 v158, v158
    v_exp_f32 v190, v190
    v_exp_f32 v159, v159
    v_exp_f32 v191, v191
    v_exp_f32 v160, v160
    v_exp_f32 v192, v192
    v_exp_f32 v161, v161
    v_exp_f32 v193, v193
    v_exp_f32 v162, v162
    v_exp_f32 v194, v194
    v_exp_f32 v163, v163
    v_exp_f32 v195, v195
    v_pk_add_f32 v[196:197], v[148:149], v[150:151]
    v_pk_add_f32 v[198:199], v[180:181], v[182:183]
    v_pk_add_f32 v[196:197], v[196:197], v[152:153]
    v_pk_add_f32 v[198:199], v[198:199], v[184:185]
    v_pk_add_f32 v[196:197], v[196:197], v[154:155]
    v_pk_add_f32 v[198:199], v[198:199], v[186:187]
    v_pk_add_f32 v[196:197], v[196:197], v[156:157]
    v_pk_add_f32 v[198:199], v[198:199], v[188:189]
    v_pk_add_f32 v[196:197], v[196:197], v[158:159]
    v_pk_add_f32 v[198:199], v[198:199], v[190:191]
    v_pk_add_f32 v[196:197], v[196:197], v[160:161]
    v_pk_add_f32 v[198:199], v[198:199], v[192:193]
    v_pk_add_f32 v[196:197], v[196:197], v[162:163]
    v_pk_add_f32 v[198:199], v[198:199], v[194:195]
    v_add_f32 v196, v196, v197
    v_add_f32 v198, v198, v199
    v_mov_b32 v200, v196
    v_mov_b32 v201, v198
    s_nop 0
    v_permlane32_swap_b32 v200, v196
    v_permlane32_swap_b32 v201, v198
    v_add_f32 v196, v200, v196
    v_add_f32 v198, v201, v198
    v_rcp_f32 v196, v196
    v_rcp_f32 v198, v198
    v_cvt_pk_bf16_f32 v64, v148, v149
    v_cvt_pk_bf16_f32 v65, v150, v151
    v_cvt_pk_bf16_f32 v66, v152, v153
    v_cvt_pk_bf16_f32 v67, v154, v155
    v_cvt_pk_bf16_f32 v68, v156, v157
    v_cvt_pk_bf16_f32 v69, v158, v159
    v_cvt_pk_bf16_f32 v70, v160, v161
    v_cvt_pk_bf16_f32 v71, v162, v163
    v_cvt_pk_bf16_f32 v72, v180, v181
    v_cvt_pk_bf16_f32 v73, v182, v183
    v_cvt_pk_bf16_f32 v74, v184, v185
    v_cvt_pk_bf16_f32 v75, v186, v187
    v_cvt_pk_bf16_f32 v76, v188, v189
    v_cvt_pk_bf16_f32 v77, v190, v191
    v_cvt_pk_bf16_f32 v78, v192, v193
    v_cvt_pk_bf16_f32 v79, v194, v195
    v_mov_b32 v100, v196
    v_mov_b32 v101, v198
    v_max3_f32 v196, v164, v165, v166
    v_min3_f32 v198, v164, v165, v166
    v_max3_f32 v196, v196, v167, v168
    v_min3_f32 v198, v198, v167, v168
    v_max3_f32 v196, v196, v169, v170
    v_min3_f32 v198, v198, v169, v170
    v_max3_f32 v196, v196, v171, v172
    v_min3_f32 v198, v198, v171, v172
    v_max3_f32 v196, v196, v173, v174
    v_min3_f32 v198, v198, v173, v174
    v_max3_f32 v196, v196, v175, v176
    v_min3_f32 v198, v198, v175, v176
    v_max3_f32 v196, v196, v177, v178
    v_min3_f32 v198, v198, v177, v178
    v_max_f32 v196, v196, v179
    v_min_f32 v198, v198, v179
    v_mov_b32 v200, v196
    v_mov_b32 v201, v198
    s_nop 0
    v_permlane32_swap_b32 v200, v196
    v_permlane32_swap_b32 v201, v198
    v_max_f32 v196, v200, v196
    v_min_f32 v198, v201, v198
    v_pk_add_f32 v[180:181], v[198:199], v[164:165] op_sel_hi:[0,1] neg_lo:[0,1] neg_hi:[0,1]
    v_pk_add_f32 v[164:165], v[164:165], v[196:197] op_sel_hi:[1,0] neg_lo:[0,1] neg_hi:[0,1]
    v_pk_add_f32 v[182:183], v[198:199], v[166:167] op_sel_hi:[0,1] neg_lo:[0,1] neg_hi:[0,1]
    v_pk_add_f32 v[166:167], v[166:167], v[196:197] op_sel_hi:[1,0] neg_lo:[0,1] neg_hi:[0,1]
    v_pk_add_f32 v[184:185], v[198:199], v[168:169] op_sel_hi:[0,1] neg_lo:[0,1] neg_hi:[0,1]
    v_pk_add_f32 v[168:169], v[168:169], v[196:197] op_sel_hi:[1,0] neg_lo:[0,1] neg_hi:[0,1]
    v_pk_add_f32 v[186:187], v[198:199], v[170:171] op_sel_hi:[0,1] neg_lo:[0,1] neg_hi:[0,1]
    v_pk_add_f32 v[170:171], v[170:171], v[196:197] op_sel_hi:[1,0] neg_lo:[0,1] neg_hi:[0,1]
    v_pk_add_f32 v[188:189], v[198:199], v[172:173] op_sel_hi:[0,1] neg_lo:[0,1] neg_hi:[0,1]
    v_pk_add_f32 v[172:173], v[172:173], v[196:197] op_sel_hi:[1,0] neg_lo:[0,1] neg_hi:[0,1]
    v_pk_add_f32 v[190:191], v[198:199], v[174:175] op_sel_hi:[0,1] neg_lo:[0,1] neg_hi:[0,1]
    v_pk_add_f32 v[174:175], v[174:175], v[196:197] op_sel_hi:[1,0] neg_lo:[0,1] neg_hi:[0,1]
    v_pk_add_f32 v[192:193], v[198:199], v[176:177] op_sel_hi:[0,1] neg_lo:[0,1] neg_hi:[0,1]
    v_pk_add_f32 v[176:177], v[176:177], v[196:197] op_sel_hi:[1,0] neg_lo:[0,1] neg_hi:[0,1]
    v_pk_add_f32 v[194:195], v[198:199], v[178:179] op_sel_hi:[0,1] neg_lo:[0,1] neg_hi:[0,1]
    v_pk_add_f32 v[178:179], v[178:179], v[196:197] op_sel_hi:[1,0] neg_lo:[0,1] neg_hi:[0,1]
    v_exp_f32 v164, v164
    buffer_load_dword v18, v17, s[4:7], s56 offen sc1
    v_exp_f32 v180, v180
    v_exp_f32 v165, v165
    v_exp_f32 v181, v181
    v_exp_f32 v166, v166
    v_exp_f32 v182, v182
    v_exp_f32 v167, v167
    v_exp_f32 v183, v183
    v_exp_f32 v168, v168
    v_exp_f32 v184, v184
    v_exp_f32 v169, v169
    v_exp_f32 v185, v185
    v_exp_f32 v170, v170
    v_exp_f32 v186, v186
    v_exp_f32 v171, v171
    v_exp_f32 v187, v187
    v_exp_f32 v172, v172
    v_exp_f32 v188, v188
    v_exp_f32 v173, v173
    v_exp_f32 v189, v189
    v_exp_f32 v174, v174
    v_exp_f32 v190, v190
    v_exp_f32 v175, v175
    v_exp_f32 v191, v191
    v_exp_f32 v176, v176
    v_exp_f32 v192, v192
    v_exp_f32 v177, v177
    v_exp_f32 v193, v193
    v_exp_f32 v178, v178
    v_exp_f32 v194, v194
    v_exp_f32 v179, v179
    v_exp_f32 v195, v195
    v_pk_add_f32 v[196:197], v[164:165], v[166:167]
    v_pk_add_f32 v[198:199], v[180:181], v[182:183]
    v_pk_add_f32 v[196:197], v[196:197], v[168:169]
    v_pk_add_f32 v[198:199], v[198:199], v[184:185]
    v_pk_add_f32 v[196:197], v[196:197], v[170:171]
    v_pk_add_f32 v[198:199], v[198:199], v[186:187]
    v_pk_add_f32 v[196:197], v[196:197], v[172:173]
    v_pk_add_f32 v[198:199], v[198:199], v[188:189]
    v_pk_add_f32 v[196:197], v[196:197], v[174:175]
    v_pk_add_f32 v[198:199], v[198:199], v[190:191]
    v_pk_add_f32 v[196:197], v[196:197], v[176:177]
    v_pk_add_f32 v[198:199], v[198:199], v[192:193]
    v_pk_add_f32 v[196:197], v[196:197], v[178:179]
    v_pk_add_f32 v[198:199], v[198:199], v[194:195]
    v_add_f32 v196, v196, v197
    v_add_f32 v198, v198, v199
    v_mov_b32 v200, v196
    v_mov_b32 v201, v198
    s_nop 0
    v_permlane32_swap_b32 v200, v196
    v_permlane32_swap_b32 v201, v198
    v_add_f32 v196, v200, v196
    v_add_f32 v198, v201, v198
    v_rcp_f32 v196, v196
    v_rcp_f32 v198, v198
    v_cvt_pk_bf16_f32 v80, v164, v165
    v_cvt_pk_bf16_f32 v81, v166, v167
    v_cvt_pk_bf16_f32 v82, v168, v169
    v_cvt_pk_bf16_f32 v83, v170, v171
    v_cvt_pk_bf16_f32 v84, v172, v173
    v_cvt_pk_bf16_f32 v85, v174, v175
    v_cvt_pk_bf16_f32 v86, v176, v177
    v_cvt_pk_bf16_f32 v87, v178, v179
    v_cvt_pk_bf16_f32 v88, v180, v181
    v_cvt_pk_bf16_f32 v89, v182, v183
    v_cvt_pk_bf16_f32 v90, v184, v185
    v_cvt_pk_bf16_f32 v91, v186, v187
    v_cvt_pk_bf16_f32 v92, v188, v189
    v_cvt_pk_bf16_f32 v93, v190, v191
    v_cvt_pk_bf16_f32 v94, v192, v193
    v_cvt_pk_bf16_f32 v95, v194, v195
    v_mov_b32 v102, v196
    v_mov_b32 v103, v198
    s_cmp_lg_u32 s3, 0
    s_cbranch_scc1 L_fr_d
    s_waitcnt vmcnt(0)
    v_cmp_le_u32 s[54:55], s34, v18
    s_nop 0
    s_cmp_eq_u64 s[54:55], exec
    s_cbranch_scc1 L_fr_d
    s_mov_b32 s57, 15
    s_call_b64 s[48:49], L_poll
L_fr_d:
    s_barrier
    s_add_u32 s34, s34, 1
    s_lshl_b32 s40, s21, 13
    s_add_u32 s40, s40, s33
    s_add_u32 s40, s40, 22282240
    s_add_u32 s41, s40, 4096
    s_lshl_b32 s42, s21, 8
    s_add_u32 s42, s42, s33
    s_add_u32 s42, s42, 22544384
    v_lshrrev_b32 v132, 5, v1
    v_lshlrev_b32 v132, 5, v132
    buffer_load_dwordx4 v[136:139], v2, s[4:7], s40 offen offset:0 sc1
    buffer_load_dwordx4 v[140:143], v2, s[4:7], s40 offen offset:1024 sc1
    buffer_load_dwordx4 v[144:147], v2, s[4:7], s40 offen offset:2048 sc1
    buffer_load_dwordx4 v[148:151], v2, s[4:7], s40 offen offset:3072 sc1
    buffer_load_dwordx4 v[168:171], v132, s[4:7], s42 offen offset:0 sc1
    buffer_load_dwordx4 v[172:175], v132, s[4:7], s42 offen offset:16 sc1
    buffer_load_dwordx4 v[176:179], v132, s[4:7], s42 offen offset:64 sc1
    buffer_load_dwordx4 v[180:183], v132, s[4:7], s42 offen offset:80 sc1
    buffer_load_dwordx4 v[152:155], v2, s[4:7], s41 offen offset:0 sc1
    buffer_load_dwordx4 v[156:159], v2, s[4:7], s41 offen offset:1024 sc1
    buffer_load_dwordx4 v[160:163], v2, s[4:7], s41 offen offset:2048 sc1
    buffer_load_dwordx4 v[164:167], v2, s[4:7], s41 offen offset:3072 sc1
    buffer_load_dwordx4 v[184:187], v132, s[4:7], s42 offen offset:128 sc1
    buffer_load_dwordx4 v[188:191], v132, s[4:7], s42 offen offset:144 sc1
    buffer_load_dwordx4 v[192:195], v132, s[4:7], s42 offen offset:192 sc1
    buffer_load_dwordx4 v[196:199], v132, s[4:7], s42 offen offset:208 sc1
    v_mov_b32 v232, 0
    v_mov_b32 v233, 0
    s_waitcnt vmcnt(8)
    v_dot2c_f32_bf16 v232, v64, v168
    v_dot2c_f32_bf16 v233, v72, v176
    v_dot2c_f32_bf16 v232, v65, v169
    v_dot2c_f32_bf16 v233, v73, v177
    v_dot2c_f32_bf16 v232, v66, v170
    v_dot2c_f32_bf16 v233, v74, v178
    v_dot2c_f32_bf16 v232, v67, v171
    v_dot2c_f32_bf16 v233, v75, v179
    v_dot2c_f32_bf16 v232, v68, v172
    v_dot2c_f32_bf16 v233, v76, v180
    v_dot2c_f32_bf16 v232, v69, v173
    v_dot2c_f32_bf16 v233, v77, v181
    v_dot2c_f32_bf16 v232, v70, v174
    v_dot2c_f32_bf16 v233, v78, v182
    v_dot2c_f32_bf16 v232, v71, v175
    v_dot2c_f32_bf16 v233, v79, v183
    v_mfma_f32_32x32x16_bf16 v[200:215], v[136:139], v[64:67], 0
    v_mfma_f32_32x32x16_bf16 v[200:215], v[140:143], v[68:71], v[200:215]
    v_mfma_f32_32x32x16_bf16 v[216:231], v[144:147], v[72:75], 0
    v_mfma_f32_32x32x16_bf16 v[216:231], v[148:151], v[76:79], v[216:231]
    v_mul_f32 v232, v232, v100
    v_fma_f32 v232, v233, v101, v232
    v_mov_b32 v233, v232
    s_nop 1
    v_permlane32_swap_b32 v233, v232
    v_add_f32 v232, v233, v232
    v_add_f32 v232, 0x358637bd, v232
    v_rcp_f32 v232, v232
    s_nop 0
    v_mul_f32 v234, v100, v232
    v_mul_f32 v236, v101, v232
    v_pk_mul_f32 v[200:201], v[200:201], v[234:235] op_sel_hi:[1,0]
    v_pk_fma_f32 v[200:201], v[216:217], v[236:237], v[200:201] op_sel_hi:[1,0,1]
    v_pk_mul_f32 v[202:203], v[202:203], v[234:235] op_sel_hi:[1,0]
    v_pk_fma_f32 v[202:203], v[218:219], v[236:237], v[202:203] op_sel_hi:[1,0,1]
    v_pk_mul_f32 v[204:205], v[204:205], v[234:235] op_sel_hi:[1,0]
    v_pk_fma_f32 v[204:205], v[220:221], v[236:237], v[204:205] op_sel_hi:[1,0,1]
    v_pk_mul_f32 v[206:207], v[206:207], v[234:235] op_sel_hi:[1,0]
    v_pk_fma_f32 v[206:207], v[222:223], v[236:237], v[206:207] op_sel_hi:[1,0,1]
    v_pk_mul_f32 v[208:209], v[208:209], v[234:235] op_sel_hi:[1,0]
    v_pk_fma_f32 v[208:209], v[224:225], v[236:237], v[208:209] op_sel_hi:[1,0,1]
    v_pk_mul_f32 v[210:211], v[210:211], v[234:235] op_sel_hi:[1,0]
    v_pk_fma_f32 v[210:211], v[226:227], v[236:237], v[210:211] op_sel_hi:[1,0,1]
    v_pk_mul_f32 v[212:213], v[212:213], v[234:235] op_sel_hi:[1,0]
    v_pk_fma_f32 v[212:213], v[228:229], v[236:237], v[212:213] op_sel_hi:[1,0,1]
    v_pk_mul_f32 v[214:215], v[214:215], v[234:235] op_sel_hi:[1,0]
    v_pk_fma_f32 v[214:215], v[230:231], v[236:237], v[214:215] op_sel_hi:[1,0,1]
    v_cvt_pk_bf16_f32 v32, v200, v201
    v_cvt_pk_bf16_f32 v33, v202, v203
    v_cvt_pk_bf16_f32 v34, v204, v205
    v_cvt_pk_bf16_f32 v35, v206, v207
    v_cvt_pk_bf16_f32 v36, v208, v209
    v_cvt_pk_bf16_f32 v37, v210, v211
    v_cvt_pk_bf16_f32 v38, v212, v213
    v_cvt_pk_bf16_f32 v39, v214, v215
    v_mov_b32 v232, 0
    v_mov_b32 v233, 0
    s_waitcnt vmcnt(0)
    v_dot2c_f32_bf16 v232, v80, v184
    v_dot2c_f32_bf16 v233, v88, v192
    v_dot2c_f32_bf16 v232, v81, v185
    v_dot2c_f32_bf16 v233, v89, v193
    v_dot2c_f32_bf16 v232, v82, v186
    v_dot2c_f32_bf16 v233, v90, v194
    v_dot2c_f32_bf16 v232, v83, v187
    v_dot2c_f32_bf16 v233, v91, v195
    v_dot2c_f32_bf16 v232, v84, v188
    v_dot2c_f32_bf16 v233, v92, v196
    v_dot2c_f32_bf16 v232, v85, v189
    v_dot2c_f32_bf16 v233, v93, v197
    v_dot2c_f32_bf16 v232, v86, v190
    v_dot2c_f32_bf16 v233, v94, v198
    v_dot2c_f32_bf16 v232, v87, v191
    v_dot2c_f32_bf16 v233, v95, v199
    v_mfma_f32_32x32x16_bf16 v[200:215], v[152:155], v[80:83], 0
    v_mfma_f32_32x32x16_bf16 v[200:215], v[156:159], v[84:87], v[200:215]
    v_mfma_f32_32x32x16_bf16 v[216:231], v[160:163], v[88:91], 0
    v_mfma_f32_32x32x16_bf16 v[216:231], v[164:167], v[92:95], v[216:231]
    v_mul_f32 v232, v232, v102
    v_fma_f32 v232, v233, v103, v232
    v_mov_b32 v233, v232
    s_nop 1
    v_permlane32_swap_b32 v233, v232
    v_add_f32 v232, v233, v232
    v_add_f32 v232, 0x358637bd, v232
    v_rcp_f32 v232, v232
    s_nop 0
    v_mul_f32 v234, v102, v232
    v_mul_f32 v236, v103, v232
    v_pk_mul_f32 v[200:201], v[200:201], v[234:235] op_sel_hi:[1,0]
    v_pk_fma_f32 v[200:201], v[216:217], v[236:237], v[200:201] op_sel_hi:[1,0,1]
    v_pk_mul_f32 v[202:203], v[202:203], v[234:235] op_sel_hi:[1,0]
    v_pk_fma_f32 v[202:203], v[218:219], v[236:237], v[202:203] op_sel_hi:[1,0,1]
    v_pk_mul_f32 v[204:205], v[204:205], v[234:235] op_sel_hi:[1,0]
    v_pk_fma_f32 v[204:205], v[220:221], v[236:237], v[204:205] op_sel_hi:[1,0,1]
    v_pk_mul_f32 v[206:207], v[206:207], v[234:235] op_sel_hi:[1,0]
    v_pk_fma_f32 v[206:207], v[222:223], v[236:237], v[206:207] op_sel_hi:[1,0,1]
    v_pk_mul_f32 v[208:209], v[208:209], v[234:235] op_sel_hi:[1,0]
    v_pk_fma_f32 v[208:209], v[224:225], v[236:237], v[208:209] op_sel_hi:[1,0,1]
    v_pk_mul_f32 v[210:211], v[210:211], v[234:235] op_sel_hi:[1,0]
    v_pk_fma_f32 v[210:211], v[226:227], v[236:237], v[210:211] op_sel_hi:[1,0,1]
    v_pk_mul_f32 v[212:213], v[212:213], v[234:235] op_sel_hi:[1,0]
    v_pk_fma_f32 v[212:213], v[228:229], v[236:237], v[212:213] op_sel_hi:[1,0,1]
    v_pk_mul_f32 v[214:215], v[214:215], v[234:235] op_sel_hi:[1,0]
    v_pk_fma_f32 v[214:215], v[230:231], v[236:237], v[214:215] op_sel_hi:[1,0,1]
    v_cvt_pk_bf16_f32 v40, v200, v201
    v_cvt_pk_bf16_f32 v41, v202, v203
    v_cvt_pk_bf16_f32 v42, v204, v205
    v_cvt_pk_bf16_f32 v43, v206, v207
    v_cvt_pk_bf16_f32 v44, v208, v209
    v_cvt_pk_bf16_f32 v45, v210, v211
    v_cvt_pk_bf16_f32 v46, v212, v213
    v_cvt_pk_bf16_f32 v47, v214, v215
    s_add_u32 s40, s23, s33
    s_add_u32 s40, s40, 8388608
    buffer_store_dwordx4 v[32:35], v2, s[4:7], s40 offen offset:0 sc1
    buffer_store_dwordx4 v[36:39], v2, s[4:7], s40 offen offset:1024 sc1
    buffer_store_dwordx4 v[40:43], v2, s[4:7], s40 offen offset:2048 sc1
    buffer_store_dwordx4 v[44:47], v2, s[4:7], s40 offen offset:3072 sc1
    s_waitcnt vmcnt(0)
    s_barrier
    s_cmp_lg_u32 s3, 0
    s_cbranch_scc1 L_pub5
    v_mov_b32 v4, s34
    s_mov_b64 exec, 1
    buffer_store_dword v4, v27, s[4:7], s60 offen sc1
    s_mov_b64 exec, -1
L_pub5:
    s_mov_b32 s20, s92
    s_mov_b32 s21, s93
    s_call_b64 s[30:31], L_usemap
    s_mov_b32 s52, 65536
    s_call_b64 s[30:31], L_grp2
    s_cmp_lg_u32 s39, 0
    s_cbranch_scc1 L_mtf_d
    s_and_b32 s40, s95, 7
    s_lshl_b32 s40, s40, 15
    s_add_u32 s40, s40, 46137344
    s_lshl_b32 s41, s3, 12
    s_add_u32 s40, s40, s41
    s_add_u32 m0, s41, 135168
    s_nop 0
    buffer_load_dwordx4 v2, s[4:7], s40 offen offset:0 sc1 lds
    buffer_load_dwordx4 v2, s[4:7], s40 offen offset:1024 sc1 lds
    buffer_load_dwordx4 v2, s[4:7], s40 offen offset:2048 sc1 lds
    buffer_load_dwordx4 v2, s[4:7], s40 offen offset:3072 sc1 lds
    s_sub_u32 s40, s40, s41
    s_add_u32 s40, s40, 16384
    s_mov_b32 m0, 151552
    s_nop 0
    buffer_load_dwordx4 v2, s[4:7], s40 offen sc1 lds
L_mtf_d:
    s_cmp_lg_u32 s39, 0
    s_cbranch_scc1 L_nores
    s_add_u32 s40, s23, s33
    s_add_u32 s40, s40, 0
    buffer_load_dwordx4 v[240:243], v2, s[4:7], s40 offen offset:0 sc1
    buffer_load_dwordx4 v[244:247], v2, s[4:7], s40 offen offset:1024 sc1
    buffer_load_dwordx4 v[248:251], v2, s[4:7], s40 offen offset:2048 sc1
    buffer_load_dwordx4 v[252:255], v2, s[4:7], s40 offen offset:3072 sc1
L_nores:
    s_and_b32 s56, s60, 0xfffff0ff
    s_cmp_lg_u32 s3, 0
    s_cbranch_scc1 L_wd6
    s_mov_b32 s57, 15
    s_call_b64 s[48:49], L_poll
L_wd6:
    s_barrier
    s_add_u32 s34, s34, 1
    s_lshl_b32 s36, s22, 16
    s_add_u32 s36, s36, s33
    s_add_u32 s36, s36, 8388608
    s_call_b64 s[30:31], L_x0
    s_mov_b64 vcc, 0
    s_call_b64 s[30:31], L_passF
    s_call_b64 s[30:31], L_resid
    s_add_u32 s44, s33, 4194304
    s_add_u32 s45, s33, 21495808
    s_call_b64 s[30:31], L_xout
    s_waitcnt vmcnt(0)
    s_barrier
    s_cmp_lg_u32 s3, 0
    s_cbranch_scc1 L_pub7
    v_mov_b32 v4, s34
    s_mov_b64 exec, 1
    buffer_store_dword v4, v27, s[4:7], s60 offen sc1
    s_mov_b64 exec, -1
L_pub7:
    s_mov_b32 s20, s94
    s_mov_b32 s21, s95
    s_call_b64 s[30:31], L_usemap
    s_mov_b32 s8, s86
    s_mov_b32 s9, s87
    s_mov_b32 s10, 268435456
    s_lshl_b32 s24, s95, 17
    s_add_u32 s24, s24, 39845888
    s_mov_b32 s25, 8192
    v_mov_b32 v6, v20
    v_mov_b32 v7, v20
    s_and_b32 s56, s60, 0xfffff0ff
    s_mov_b32 s52, 0
    s_call_b64 s[30:31], L_grp2
    buffer_load_dword v18, v17, s[4:7], s56 offen sc1
    s_mov_b32 s52, 65536
    s_call_b64 s[30:31], L_grp2
    s_cmp_lg_u32 s39, 0
    s_cbranch_scc1 L_mcs_d
    v_mov_b32 v140, 0x3f803f80
    v_mov_b32 v141, v140
    v_mov_b32 v142, v140
    v_mov_b32 v143, v140
    s_mul_i32 s40, s3, 4352
    v_add_u32 v136, s40, v19
    ds_read_b128 v[148:151], v136 offset:0
    ds_read_b128 v[152:155], v136 offset:272
    ds_read_b128 v[156:159], v136 offset:544
    ds_read_b128 v[160:163], v136 offset:816
    ds_read_b128 v[164:167], v136 offset:1088
    ds_read_b128 v[168:171], v136 offset:1360
    ds_read_b128 v[172:175], v136 offset:1632
    ds_read_b128 v[176:179], v136 offset:1904
    ds_read_b128 v[180:183], v136 offset:2176
    ds_read_b128 v[184:187], v136 offset:2448
    ds_read_b128 v[188:191], v136 offset:2720
    ds_read_b128 v[192:195], v136 offset:2992
    ds_read_b128 v[196:199], v136 offset:3264
    ds_read_b128 v[200:203], v136 offset:3536
    ds_read_b128 v[204:207], v136 offset:3808
    ds_read_b128 v[208:211], v136 offset:4080
    s_lshl_b32 s40, s3, 5
    s_add_u32 s40, s40, 153088
    v_lshrrev_b32 v137, 5, v1
    v_lshl_add_u32 v137, v137, 4, s40
    s_waitcnt lgkmcnt(0)
    v_mfma_f32_16x16x32_bf16 v[144:147], v[148:151], v[140:143], 0
    v_mfma_f32_16x16x32_bf16 v[144:147], v[152:155], v[140:143], v[144:147]
    v_mfma_f32_16x16x32_bf16 v[144:147], v[156:159], v[140:143], v[144:147]
    v_mfma_f32_16x16x32_bf16 v[144:147], v[160:163], v[140:143], v[144:147]
    v_mfma_f32_16x16x32_bf16 v[144:147], v[164:167], v[140:143], v[144:147]
    v_mfma_f32_16x16x32_bf16 v[144:147], v[168:171], v[140:143], v[144:147]
    v_mfma_f32_16x16x32_bf16 v[144:147], v[172:175], v[140:143], v[144:147]
    v_mfma_f32_16x16x32_bf16 v[144:147], v[176:179], v[140:143], v[144:147]
    v_mfma_f32_16x16x32_bf16 v[144:147], v[180:183], v[140:143], v[144:147]
    v_mfma_f32_16x16x32_bf16 v[144:147], v[184:187], v[140:143], v[144:147]
    v_mfma_f32_16x16x32_bf16 v[144:147], v[188:191], v[140:143], v[144:147]
    v_mfma_f32_16x16x32_bf16 v[144:147], v[192:195], v[140:143], v[144:147]
    v_mfma_f32_16x16x32_bf16 v[144:147], v[196:199], v[140:143], v[144:147]
    v_mfma_f32_16x16x32_bf16 v[144:147], v[200:203], v[140:143], v[144:147]
    v_mfma_f32_16x16x32_bf16 v[144:147], v[204:207], v[140:143], v[144:147]
    v_mfma_f32_16x16x32_bf16 v[144:147], v[208:211], v[140:143], v[144:147]
    s_nop 7
    ds_write_b128 v137, v[144:147]
    s_waitcnt lgkmcnt(0)
L_mcs_d:
    s_cmp_lg_u32 s3, 0
    s_cbranch_scc1 L_rw8
    s_waitcnt vmcnt(16)
    v_cmp_le_u32 s[54:55], s34, v18
    s_nop 0
    s_cmp_eq_u64 s[54:55], exec
    s_cbranch_scc1 L_rw8
    s_mov_b32 s57, 15
    s_call_b64 s[48:49], L_poll
L_rw8:
    s_waitcnt lgkmcnt(0)
    s_barrier
    s_add_u32 s34, s34, 1
    s_lshl_b32 s40, s22, 12
    s_add_u32 s40, s40, s33
    s_add_u32 s40, s40, 21495808
    v_and_b32 v4, 31, v1
    v_lshrrev_b32 v5, 5, v1
    v_lshlrev_b32 v4, 3, v4
    v_lshl_add_u32 v4, v5, 11, v4
    buffer_load_dwordx2 v[116:117], v4, s[4:7], s40 offen offset:0 sc1
    buffer_load_dwordx2 v[118:119], v4, s[4:7], s40 offen offset:256 sc1
    buffer_load_dwordx2 v[120:121], v4, s[4:7], s40 offen offset:512 sc1
    buffer_load_dwordx2 v[122:123], v4, s[4:7], s40 offen offset:768 sc1
    buffer_load_dwordx2 v[124:125], v4, s[4:7], s40 offen offset:1024 sc1
    buffer_load_dwordx2 v[126:127], v4, s[4:7], s40 offen offset:1280 sc1
    buffer_load_dwordx2 v[128:129], v4, s[4:7], s40 offen offset:1536 sc1
    buffer_load_dwordx2 v[130:131], v4, s[4:7], s40 offen offset:1792 sc1
    s_lshl_b32 s36, s22, 16
    s_add_u32 s36, s36, s33
    s_add_u32 s36, s36, 4194304
    s_call_b64 s[30:31], L_x0
    s_waitcnt vmcnt(8)
    s_call_b64 s[30:31], L_stats
    s_cmp_lt_u32 s21, 8
    s_cbranch_scc1 L_b_mini
    s_mov_b64 vcc, 0
    s_call_b64 s[30:31], L_passF
    s_branch L_kv_done
L_b_mini:
    s_call_b64 s[30:31], L_passB
    s_lshl_b32 s42, s22, 12
    s_add_u32 s42, s42, s33
    s_add_u32 s42, s42, 21757952
    v_lshrrev_b32 v133, 5, v1
    v_lshlrev_b32 v132, 4, v133
    v_add_u32 v132, 153088, v132
    ds_read_b128 v[136:139], v132
    ds_read_b128 v[140:143], v132 offset:32
    ds_read_b128 v[144:147], v132 offset:64
    ds_read_b128 v[148:151], v132 offset:96
    s_cmp_ge_u32 s21, 4
    s_cbranch_scc1 L_kv_v0
    s_lshl_b32 s40, s21, 9
    s_add_u32 s42, s42, s40
    v_and_b32 v134, 31, v1
    v_lshlrev_b32 v134, 4, v134
    v_lshl_add_u32 v134, v133, 3, v134
    s_branch L_kv_c
L_kv_v0:
    s_and_b32 s40, s21, 3
    s_lshl_b32 s40, s40, 7
    s_add_u32 s42, s42, s40
    s_add_u32 s42, s42, 2048
    v_lshlrev_b32 v134, 6, v133
    v_and_b32 v135, 3, v1
    v_lshl_add_u32 v134, v135, 4, v134
    v_bfe_u32 v135, v1, 4, 1
    v_lshl_add_u32 v134, v135, 10, v134
    v_bfe_u32 v135, v1, 2, 1
    v_lshl_add_u32 v134, v135, 9, v134
    v_bfe_u32 v135, v1, 3, 1
    v_lshl_add_u32 v134, v135, 3, v134
L_kv_c:
    s_waitcnt lgkmcnt(0)
    v_pk_add_f32 v[136:137], v[136:137], v[140:141]
    v_pk_add_f32 v[138:139], v[138:139], v[142:143]
    v_pk_add_f32 v[144:145], v[144:145], v[148:149]
    v_pk_add_f32 v[146:147], v[146:147], v[150:151]
    v_pk_add_f32 v[136:137], v[136:137], v[144:145]
    v_pk_add_f32 v[138:139], v[138:139], v[146:147]
    v_fma_f32 v188, v136, v31, v188
    v_mul_f32 v188, v188, v30
    v_fma_f32 v189, v137, v31, v189
    v_mul_f32 v189, v189, v30
    v_fma_f32 v190, v138, v31, v190
    v_mul_f32 v190, v190, v30
    v_fma_f32 v191, v139, v31, v191
    v_mul_f32 v191, v191, v30
    v_cvt_pk_bf16_f32 v188, v188, v189
    v_cvt_pk_bf16_f32 v189, v190, v191
    s_cmp_lt_u32 s21, 4
    s_cbranch_scc1 L_kv_d
    s_lshl_b32 s41, s3, 9
    s_add_u32 s41, s41, 155648
    v_add_u32 v132, s41, v3
    ds_write_b64 v132, v[188:189]
    v_and_b32 v132, 48, v1
    v_and_b32 v133, 3, v1
    v_lshl_add_u32 v132, v133, 2, v132
    v_bfe_u32 v133, v1, 2, 2
    v_add_u32 v132, v132, v133
    v_lshl_add_u32 v132, v132, 3, s41
    s_waitcnt lgkmcnt(0)
    ds_read_b64_tr_b16 v[188:189], v132
    s_waitcnt lgkmcnt(0)
L_kv_d:
    buffer_store_dwordx2 v[188:189], v134, s[4:7], s42 offen sc1
L_kv_done:
    s_mov_b32 s63, 0
    s_mov_b32 s53, 155136
    v_mul_f32 v134, 0x3e8293ee, v30
    s_call_b64 s[30:31], L_ln
    s_lshl_b32 s40, s3, 11
    s_add_u32 s40, s40, 114688
    v_add_u32 v132, s40, v2
    s_lshl_b32 s45, s20, 8
    s_lshl_b32 s44, s21, 2
    s_add_u32 s45, s45, s44
    s_add_u32 s45, s45, 32112640
    s_waitcnt vmcnt(0)
    s_barrier
    s_cmp_lg_u32 s3, 0
    s_cbranch_scc1 L_pub9
    v_mov_b32 v4, s34
    s_mov_b64 exec, 1
    buffer_store_dword v4, v27, s[4:7], s45 offen sc1
    s_mov_b64 exec, -1
L_pub9:
    ds_write_b128 v132, v[116:119] offset:0
    ds_write_b128 v132, v[120:123] offset:1024
    ds_write_b128 v132, v[124:127] offset:8192
    ds_write_b128 v132, v[128:131] offset:9216
    s_mov_b32 s8, s86
    s_mov_b32 s9, s87
    s_mov_b32 s10, 268435456
    s_lshl_b32 s24, s93, 17
    s_add_u32 s24, s24, 44040192
    s_mov_b32 s25, 8192
    v_mov_b32 v6, v20
    v_mov_b32 v7, v20
    s_mov_b32 s52, 0
    s_call_b64 s[30:31], L_grp2
    s_waitcnt lgkmcnt(0)
    s_barrier
    s_lshr_b32 s40, s3, 1
    s_lshl_b32 s40, s40, 1
    s_add_u32 s40, s40, 0
    s_and_b32 s40, s40, 3
    s_and_b32 s42, s3, 1
    s_lshl_b32 s41, s42, 2
    s_add_u32 s41, s41, s40
    s_lshl_b32 s41, s41, 11
    s_add_u32 s41, s41, 114688
    v_add_u32 v176, s41, v2
    ds_read_b128 a[64:67], v176
    ds_read_b128 a[68:71], v176 offset:1024
    s_lshl_b32 s41, s20, 2
    s_add_u32 s41, s41, s40
    s_lshl_b32 s41, s41, 16
    s_lshl_b32 s42, s42, 11
    s_add_u32 s41, s41, s42
    s_lshl_b32 s40, s21, 12
    s_add_u32 s41, s41, s40
    s_add_u32 s41, s41, s33
    s_add_u32 s46, s41, 12582912
    s_lshr_b32 s40, s3, 1
    s_lshl_b32 s40, s40, 1
    s_add_u32 s40, s40, 1
    s_and_b32 s40, s40, 3
    s_and_b32 s42, s3, 1
    s_lshl_b32 s41, s42, 2
    s_add_u32 s41, s41, s40
    s_lshl_b32 s41, s41, 11
    s_add_u32 s41, s41, 114688
    v_add_u32 v176, s41, v2
    ds_read_b128 a[72:75], v176
    ds_read_b128 a[76:79], v176 offset:1024
    s_lshl_b32 s41, s20, 2
    s_add_u32 s41, s41, s40
    s_lshl_b32 s41, s41, 16
    s_lshl_b32 s42, s42, 11
    s_add_u32 s41, s41, s42
    s_lshl_b32 s40, s21, 12
    s_add_u32 s41, s41, s40
    s_add_u32 s41, s41, s33
    s_add_u32 s47, s41, 12582912
    s_lshr_b32 s40, s3, 1
    s_lshl_b32 s40, s40, 1
    s_add_u32 s40, s40, 2
    s_and_b32 s40, s40, 3
    s_and_b32 s42, s3, 1
    s_lshl_b32 s41, s42, 2
    s_add_u32 s41, s41, s40
    s_lshl_b32 s41, s41, 11
    s_add_u32 s41, s41, 114688
    v_add_u32 v176, s41, v2
    ds_read_b128 a[80:83], v176
    ds_read_b128 a[84:87], v176 offset:1024
    s_lshr_b32 s40, s3, 1
    s_lshl_b32 s40, s40, 1
    s_add_u32 s40, s40, 3
    s_and_b32 s40, s40, 3
    s_and_b32 s42, s3, 1
    s_lshl_b32 s41, s42, 2
    s_add_u32 s41, s41, s40
    s_lshl_b32 s41, s41, 11
    s_add_u32 s41, s41, 114688
    v_add_u32 v176, s41, v2
    ds_read_b128 a[88:91], v176
    ds_read_b128 a[92:95], v176 offset:1024
    v_bfe_u32 v176, v1, 2, 1
    v_cmp_eq_u32 vcc, 0, v176
    v_mov_b32 v178, 0x3f803f80
    s_nop 0
    v_cndmask_b32 v144, 0, v178, vcc
    v_mov_b32 v145, v144
    v_xor_b32 v146, v144, v178
    v_mov_b32 v147, v146
    v_and_b32 v176, 1, v1
    v_cmp_eq_u32 vcc, 0, v176
    v_mov_b32 v177, 0x4444
    v_mov_b32 v178, 0xeeee
    v_cndmask_b32 v200, v178, v177, vcc
    v_cmp_gt_u32 vcc, 32, v1
    v_mov_b32 v178, 0x3f803f80
    s_nop 0
    v_cndmask_b32 v148, 0, v178, vcc
    v_and_b32 v149, 0xffff, v148
    s_mov_b32 s29, 0
    s_lshr_b32 s50, s3, 1
    s_lshl_b32 s50, s50, 17
    s_add_u32 s50, s50, s33
    s_add_u32 s50, s50, 21757952
    v_mov_b32 v150, 0
    v_mov_b32 v151, 0
    v_mov_b32 v152, 0
    v_mov_b32 v153, 0
    v_mov_b32 v154, 0
    v_mov_b32 v155, 0
    v_mov_b32 v156, 0
    v_mov_b32 v157, 0
    v_mov_b32 v158, 0
    v_mov_b32 v159, 0
    v_mov_b32 v160, 0
    v_mov_b32 v161, 0
    v_mov_b32 v162, 0
    v_mov_b32 v163, 0
    v_mov_b32 v164, 0
    v_mov_b32 v165, 0
    v_mov_b32 v166, 0
    v_mov_b32 v167, 0
    v_mov_b32 v136, 0
    v_mov_b32 v137, 0
    v_mov_b32 v138, 0
    v_mov_b32 v139, 0
    v_mov_b32 v140, 0
    v_mov_b32 v141, 0
    v_mov_b32 v142, 0
    v_mov_b32 v143, 0
    v_mfma_f32_32x32x16_bf16 a[0:15], v[136:139], v[136:139], 0
    v_mfma_f32_32x32x16_bf16 a[16:31], v[136:139], v[136:139], 0
    v_mfma_f32_32x32x16_bf16 a[32:47], v[136:139], v[136:139], 0
    v_mfma_f32_32x32x16_bf16 a[48:63], v[136:139], v[136:139], 0
    v_mfma_f32_32x32x16_bf16 a[160:175], v[136:139], v[136:139], 0
    v_mfma_f32_32x32x16_bf16 a[144:159], v[136:139], v[136:139], 0
    s_cmp_lg_u32 s3, 0
    s_cbranch_scc1 L_akv_d
    v_bfe_u32 v176, v1, 1, 4
    v_lshlrev_b32 v176, 8, v176
    v_and_b32 v177, 1, v1
    v_lshl_add_u32 v176, v177, 4, v176
    s_mov_b32 s56, 32112640
    s_mov_b32 s35, 0
L_akv_l:
    buffer_load_dwordx4 v[180:183], v176, s[4:7], s56 offen sc1
    s_add_u32 s35, s35, 1
    s_waitcnt vmcnt(0)
    v_min_u32 v180, v180, v181
    v_min_u32 v182, v182, v183
    v_min_u32 v180, v180, v182
    v_cmp_le_u32 vcc, s34, v180
    s_nop 0
    s_cmp_eq_u64 vcc, exec
    s_cbranch_scc1 L_akv_d
    s_sleep 2
    s_cmp_lt_u32 s35, 0x40000
    s_cbranch_scc1 L_akv_l
    s_endpgm
L_akv_d:
    s_barrier
    s_add_u32 s34, s34, 1
    s_mov_b32 s36, s50
    buffer_load_dwordx4 a[96:99], v2, s[4:7], s36 offen offset:0 sc1
    buffer_load_dwordx4 a[100:103], v2, s[4:7], s36 offen offset:1024 sc1
    buffer_load_dwordx4 a[104:107], v2, s[4:7], s36 offen offset:2048 sc1
    buffer_load_dwordx4 a[108:111], v2, s[4:7], s36 offen offset:3072 sc1
    s_add_u32 s36, s36, 4096
    buffer_load_dwordx4 a[112:115], v2, s[4:7], s36 offen offset:0 sc1
    buffer_load_dwordx4 a[116:119], v2, s[4:7], s36 offen offset:1024 sc1
    buffer_load_dwordx4 a[120:123], v2, s[4:7], s36 offen offset:2048 sc1
    buffer_load_dwordx4 a[124:127], v2, s[4:7], s36 offen offset:3072 sc1
    s_add_u32 s36, s36, 4096
    buffer_load_dwordx4 a[128:131], v2, s[4:7], s36 offen offset:0 sc1
    buffer_load_dwordx4 a[132:135], v2, s[4:7], s36 offen offset:1024 sc1
    buffer_load_dwordx4 a[136:139], v2, s[4:7], s36 offen offset:2048 sc1
    buffer_load_dwordx4 a[140:143], v2, s[4:7], s36 offen offset:3072 sc1
    s_add_u32 s36, s36, 4096
    s_waitcnt vmcnt(10) lgkmcnt(0)
    v_mfma_f32_32x32x16_bf16 v[32:47], a[96:99], a[64:67], 0
    v_mfma_f32_32x32x16_bf16 v[32:47], a[100:103], a[68:71], v[32:47]
    v_mfma_f32_32x32x16_bf16 v[48:63], a[96:99], a[72:75], 0
    v_mfma_f32_32x32x16_bf16 v[48:63], a[100:103], a[76:79], v[48:63]
    v_mfma_f32_32x32x16_bf16 v[64:79], a[96:99], a[80:83], 0
    v_mfma_f32_32x32x16_bf16 v[64:79], a[100:103], a[84:87], v[64:79]
    v_mfma_f32_32x32x16_bf16 v[80:95], a[96:99], a[88:91], 0
    v_mfma_f32_32x32x16_bf16 v[80:95], a[100:103], a[92:95], v[80:95]
    s_nop 5
    v_max3_f32 v168, v32, v33, v34
    v_max3_f32 v168, v168, v35, v36
    v_max3_f32 v168, v168, v37, v38
    v_max3_f32 v168, v168, v39, v40
    v_max3_f32 v168, v168, v41, v42
    v_max3_f32 v168, v168, v43, v44
    v_max3_f32 v168, v168, v45, v46
    v_max_f32 v168, v168, v47
    v_max3_f32 v170, v48, v49, v50
    v_max3_f32 v170, v170, v51, v52
    v_max3_f32 v170, v170, v53, v54
    v_max3_f32 v170, v170, v55, v56
    v_max3_f32 v170, v170, v57, v58
    v_max3_f32 v170, v170, v59, v60
    v_max3_f32 v170, v170, v61, v62
    v_max_f32 v170, v170, v63
    v_max3_f32 v172, v64, v65, v66
    v_max3_f32 v172, v172, v67, v68
    v_max3_f32 v172, v172, v69, v70
    v_max3_f32 v172, v172, v71, v72
    v_max3_f32 v172, v172, v73, v74
    v_max3_f32 v172, v172, v75, v76
    v_max3_f32 v172, v172, v77, v78
    v_max_f32 v172, v172, v79
    v_max3_f32 v174, v80, v81, v82
    v_max3_f32 v174, v174, v83, v84
    v_max3_f32 v174, v174, v85, v86
    v_max3_f32 v174, v174, v87, v88
    v_max3_f32 v174, v174, v89, v90
    v_max3_f32 v174, v174, v91, v92
    v_max3_f32 v174, v174, v93, v94
    v_max_f32 v174, v174, v95
L_att_setmax:
    v_mov_b32 v169, v168
    v_mov_b32 v171, v170
    v_mov_b32 v173, v172
    v_mov_b32 v175, v174
    v_permlane32_swap_b32 v169, v168
    v_permlane32_swap_b32 v171, v170
    v_permlane32_swap_b32 v173, v172
    v_permlane32_swap_b32 v175, v174
    v_max_f32 v168, v168, v169
    v_sub_f32 v168, 0, v168
    v_and_b32 v176, 0xffff0000, v168
    v_sub_f32 v177, v168, v176
    v_and_b32 v178, 0xffff0000, v177
    v_sub_f32 v177, v177, v178
    v_cvt_pk_bf16_f32 v152, v176, v178
    v_cvt_pk_bf16_f32 v153, v177, 0
    v_max_f32 v170, v170, v171
    v_sub_f32 v170, 0, v170
    v_and_b32 v176, 0xffff0000, v170
    v_sub_f32 v177, v170, v176
    v_and_b32 v178, 0xffff0000, v177
    v_sub_f32 v177, v177, v178
    v_cvt_pk_bf16_f32 v156, v176, v178
    v_cvt_pk_bf16_f32 v157, v177, 0
    v_max_f32 v172, v172, v173
    v_sub_f32 v172, 0, v172
    v_and_b32 v176, 0xffff0000, v172
    v_sub_f32 v177, v172, v176
    v_and_b32 v178, 0xffff0000, v177
    v_sub_f32 v177, v177, v178
    v_cvt_pk_bf16_f32 v160, v176, v178
    v_cvt_pk_bf16_f32 v161, v177, 0
    v_max_f32 v174, v174, v175
    v_sub_f32 v174, 0, v174
    v_and_b32 v176, 0xffff0000, v174
    v_sub_f32 v177, v174, v176
    v_and_b32 v178, 0xffff0000, v177
    v_sub_f32 v177, v177, v178
    v_cvt_pk_bf16_f32 v164, v176, v178
    v_cvt_pk_bf16_f32 v165, v177, 0
    v_mfma_f32_32x32x16_bf16 v[32:47], v[148:151], v[152:155], 0
    v_mfma_f32_32x32x16_bf16 v[48:63], v[148:151], v[156:159], 0
    v_mfma_f32_32x32x16_bf16 v[64:79], v[148:151], v[160:163], 0
    v_mfma_f32_32x32x16_bf16 v[80:95], v[148:151], v[164:167], 0
    s_mov_b32 s35, 8
    s_waitcnt vmcnt(8)
    v_mfma_f32_32x32x16_bf16 v[96:111], a[96:99], a[64:67], v[32:47]
    v_mfma_f32_32x32x16_bf16 v[96:111], a[100:103], a[68:71], v[96:111]
    s_nop 7
    s_nop 3
L_att_loop:
    v_mfma_f32_32x32x16_bf16 v[112:127], a[96:99], a[72:75], v[48:63]
    v_exp_f32 v96, v96
    v_exp_f32 v97, v97
    v_exp_f32 v98, v98
    v_mfma_f32_32x32x16_bf16 v[112:127], a[100:103], a[76:79], v[112:127]
    v_exp_f32 v99, v99
    v_cvt_pk_bf16_f32 v128, v96, v97
    v_exp_f32 v100, v100
    v_exp_f32 v101, v101
    v_mfma_f32_32x32x16_bf16 a[48:63], a[152:155], v[136:139], a[48:63]
    v_cvt_pk_bf16_f32 v129, v98, v99
    v_exp_f32 v102, v102
    v_exp_f32 v103, v103
    v_cvt_pk_bf16_f32 v130, v100, v101
    v_mfma_f32_32x32x16_bf16 a[48:63], a[156:159], v[140:143], a[48:63]
    v_exp_f32 v104, v104
    v_cvt_pk_bf16_f32 v131, v102, v103
    v_exp_f32 v105, v105
    v_exp_f32 v106, v106
    v_smfmac_f32_16x16x64_bf16 a[172:175], v[144:147], v[136:143], v200
    v_exp_f32 v107, v107
    v_cvt_pk_bf16_f32 v132, v104, v105
    v_exp_f32 v108, v108
    v_exp_f32 v109, v109
    v_cvt_pk_bf16_f32 v133, v106, v107
    v_exp_f32 v110, v110
    v_exp_f32 v111, v111
    v_cvt_pk_bf16_f32 v134, v108, v109
    v_cvt_pk_bf16_f32 v135, v110, v111
    v_mfma_f32_32x32x16_bf16 v[96:111], a[96:99], a[80:83], v[64:79]
    v_exp_f32 v112, v112
    v_exp_f32 v113, v113
    v_exp_f32 v114, v114
    v_mfma_f32_32x32x16_bf16 v[96:111], a[100:103], a[84:87], v[96:111]
    v_exp_f32 v115, v115
    v_cvt_pk_bf16_f32 v136, v112, v113
    v_exp_f32 v116, v116
    v_exp_f32 v117, v117
    v_mfma_f32_32x32x16_bf16 a[0:15], a[104:107], v[128:131], a[0:15]
    buffer_load_dwordx4 a[144:147], v2, s[4:7], s36 offen offset:0 sc1
    v_cvt_pk_bf16_f32 v137, v114, v115
    v_exp_f32 v118, v118
    v_exp_f32 v119, v119
    v_cvt_pk_bf16_f32 v138, v116, v117
    v_mfma_f32_32x32x16_bf16 a[0:15], a[108:111], v[132:135], a[0:15]
    v_exp_f32 v120, v120
    v_cvt_pk_bf16_f32 v139, v118, v119
    v_exp_f32 v121, v121
    v_exp_f32 v122, v122
    v_smfmac_f32_16x16x64_bf16 a[160:163], v[144:147], v[128:135], v200
    buffer_load_dwordx4 a[148:151], v2, s[4:7], s36 offen offset:1024 sc1
    v_exp_f32 v123, v123
    v_cvt_pk_bf16_f32 v140, v120, v121
    v_exp_f32 v124, v124
    v_exp_f32 v125, v125
    v_cvt_pk_bf16_f32 v141, v122, v123
    v_exp_f32 v126, v126
    v_exp_f32 v127, v127
    v_cvt_pk_bf16_f32 v142, v124, v125
    v_cvt_pk_bf16_f32 v143, v126, v127
    v_mfma_f32_32x32x16_bf16 v[112:127], a[96:99], a[88:91], v[80:95]
    v_exp_f32 v96, v96
    v_exp_f32 v97, v97
    v_exp_f32 v98, v98
    v_mfma_f32_32x32x16_bf16 v[112:127], a[100:103], a[92:95], v[112:127]
    v_exp_f32 v99, v99
    v_cvt_pk_bf16_f32 v128, v96, v97
    v_exp_f32 v100, v100
    v_exp_f32 v101, v101
    v_mfma_f32_32x32x16_bf16 a[16:31], a[104:107], v[136:139], a[16:31]
    buffer_load_dwordx4 a[152:155], v2, s[4:7], s36 offen offset:2048 sc1
    v_cvt_pk_bf16_f32 v129, v98, v99
    v_exp_f32 v102, v102
    v_exp_f32 v103, v103
    v_cvt_pk_bf16_f32 v130, v100, v101
    v_mfma_f32_32x32x16_bf16 a[16:31], a[108:111], v[140:143], a[16:31]
    v_exp_f32 v104, v104
    v_cvt_pk_bf16_f32 v131, v102, v103
    v_exp_f32 v105, v105
    v_exp_f32 v106, v106
    v_smfmac_f32_16x16x64_bf16 a[164:167], v[144:147], v[136:143], v200
    buffer_load_dwordx4 a[156:159], v2, s[4:7], s36 offen offset:3072 sc1
    s_add_u32 s36, s36, 4096
    v_exp_f32 v107, v107
    v_cvt_pk_bf16_f32 v132, v104, v105
    v_exp_f32 v108, v108
    v_exp_f32 v109, v109
    v_cvt_pk_bf16_f32 v133, v106, v107
    v_exp_f32 v110, v110
    v_exp_f32 v111, v111
    v_cvt_pk_bf16_f32 v134, v108, v109
    v_cvt_pk_bf16_f32 v135, v110, v111
    s_waitcnt vmcnt(8)
    v_mfma_f32_32x32x16_bf16 v[96:111], a[112:115], a[64:67], v[32:47]
    v_exp_f32 v112, v112
    v_exp_f32 v113, v113
    v_exp_f32 v114, v114
    v_mfma_f32_32x32x16_bf16 v[96:111], a[116:119], a[68:71], v[96:111]
    v_exp_f32 v115, v115
    v_cvt_pk_bf16_f32 v136, v112, v113
    v_exp_f32 v116, v116
    v_exp_f32 v117, v117
    v_mfma_f32_32x32x16_bf16 a[32:47], a[104:107], v[128:131], a[32:47]
    v_cvt_pk_bf16_f32 v137, v114, v115
    v_exp_f32 v118, v118
    v_exp_f32 v119, v119
    v_cvt_pk_bf16_f32 v138, v116, v117
    v_mfma_f32_32x32x16_bf16 a[32:47], a[108:111], v[132:135], a[32:47]
    v_exp_f32 v120, v120
    v_cvt_pk_bf16_f32 v139, v118, v119
    v_exp_f32 v121, v121
    v_exp_f32 v122, v122
    v_smfmac_f32_16x16x64_bf16 a[168:171], v[144:147], v[128:135], v200
    v_exp_f32 v123, v123
    v_cvt_pk_bf16_f32 v140, v120, v121
    v_exp_f32 v124, v124
    v_exp_f32 v125, v125
    v_cvt_pk_bf16_f32 v141, v122, v123
    v_exp_f32 v126, v126
    v_exp_f32 v127, v127
    v_cvt_pk_bf16_f32 v142, v124, v125
    v_cvt_pk_bf16_f32 v143, v126, v127
    v_mfma_f32_32x32x16_bf16 v[112:127], a[112:115], a[72:75], v[48:63]
    v_exp_f32 v96, v96
    v_exp_f32 v97, v97
    v_exp_f32 v98, v98
    v_mfma_f32_32x32x16_bf16 v[112:127], a[116:119], a[76:79], v[112:127]
    v_exp_f32 v99, v99
    v_cvt_pk_bf16_f32 v128, v96, v97
    v_exp_f32 v100, v100
    v_exp_f32 v101, v101
    v_mfma_f32_32x32x16_bf16 a[48:63], a[104:107], v[136:139], a[48:63]
    v_cvt_pk_bf16_f32 v129, v98, v99
    v_exp_f32 v102, v102
    v_exp_f32 v103, v103
    v_cvt_pk_bf16_f32 v130, v100, v101
    v_mfma_f32_32x32x16_bf16 a[48:63], a[108:111], v[140:143], a[48:63]
    v_exp_f32 v104, v104
    v_cvt_pk_bf16_f32 v131, v102, v103
    v_exp_f32 v105, v105
    v_exp_f32 v106, v106
    v_smfmac_f32_16x16x64_bf16 a[172:175], v[144:147], v[136:143], v200
    v_exp_f32 v107, v107
    v_cvt_pk_bf16_f32 v132, v104, v105
    v_exp_f32 v108, v108
    v_exp_f32 v109, v109
    v_cvt_pk_bf16_f32 v133, v106, v107
    v_exp_f32 v110, v110
    v_exp_f32 v111, v111
    v_cvt_pk_bf16_f32 v134, v108, v109
    v_cvt_pk_bf16_f32 v135, v110, v111
    v_mfma_f32_32x32x16_bf16 v[96:111], a[112:115], a[80:83], v[64:79]
    v_exp_f32 v112, v112
    v_exp_f32 v113, v113
    v_exp_f32 v114, v114
    v_mfma_f32_32x32x16_bf16 v[96:111], a[116:119], a[84:87], v[96:111]
    v_exp_f32 v115, v115
    v_cvt_pk_bf16_f32 v136, v112, v113
    v_exp_f32 v116, v116
    v_exp_f32 v117, v117
    v_mfma_f32_32x32x16_bf16 a[0:15], a[120:123], v[128:131], a[0:15]
    buffer_load_dwordx4 a[96:99], v2, s[4:7], s36 offen offset:0 sc1
    v_cvt_pk_bf16_f32 v137, v114, v115
    v_exp_f32 v118, v118
    v_exp_f32 v119, v119
    v_cvt_pk_bf16_f32 v138, v116, v117
    v_mfma_f32_32x32x16_bf16 a[0:15], a[124:127], v[132:135], a[0:15]
    v_exp_f32 v120, v120
    v_cvt_pk_bf16_f32 v139, v118, v119
    v_exp_f32 v121, v121
    v_exp_f32 v122, v122
    v_smfmac_f32_16x16x64_bf16 a[160:163], v[144:147], v[128:135], v200
    buffer_load_dwordx4 a[100:103], v2, s[4:7], s36 offen offset:1024 sc1
    v_exp_f32 v123, v123
    v_cvt_pk_bf16_f32 v140, v120, v121
    v_exp_f32 v124, v124
    v_exp_f32 v125, v125
    v_cvt_pk_bf16_f32 v141, v122, v123
    v_exp_f32 v126, v126
    v_exp_f32 v127, v127
    v_cvt_pk_bf16_f32 v142, v124, v125
    v_cvt_pk_bf16_f32 v143, v126, v127
    v_mfma_f32_32x32x16_bf16 v[112:127], a[112:115], a[88:91], v[80:95]
    v_exp_f32 v96, v96
    v_exp_f32 v97, v97
    v_exp_f32 v98, v98
    v_mfma_f32_32x32x16_bf16 v[112:127], a[116:119], a[92:95], v[112:127]
    v_exp_f32 v99, v99
    v_cvt_pk_bf16_f32 v128, v96, v97
    v_exp_f32 v100, v100
    v_exp_f32 v101, v101
    v_mfma_f32_32x32x16_bf16 a[16:31], a[120:123], v[136:139], a[16:31]
    buffer_load_dwordx4 a[104:107], v2, s[4:7], s36 offen offset:2048 sc1
    v_cvt_pk_bf16_f32 v129, v98, v99
    v_exp_f32 v102, v102
    v_exp_f32 v103, v103
    v_cvt_pk_bf16_f32 v130, v100, v101
    v_mfma_f32_32x32x16_bf16 a[16:31], a[124:127], v[140:143], a[16:31]
    v_exp_f32 v104, v104
    v_cvt_pk_bf16_f32 v131, v102, v103
    v_exp_f32 v105, v105
    v_exp_f32 v106, v106
    v_smfmac_f32_16x16x64_bf16 a[164:167], v[144:147], v[136:143], v200
    buffer_load_dwordx4 a[108:111], v2, s[4:7], s36 offen offset:3072 sc1
    s_add_u32 s36, s36, 4096
    v_exp_f32 v107, v107
    v_cvt_pk_bf16_f32 v132, v104, v105
    v_exp_f32 v108, v108
    v_exp_f32 v109, v109
    v_cvt_pk_bf16_f32 v133, v106, v107
    v_exp_f32 v110, v110
    v_exp_f32 v111, v111
    v_cvt_pk_bf16_f32 v134, v108, v109
    v_cvt_pk_bf16_f32 v135, v110, v111
    s_waitcnt vmcnt(8)
    v_mfma_f32_32x32x16_bf16 v[96:111], a[128:131], a[64:67], v[32:47]
    v_exp_f32 v112, v112
    v_exp_f32 v113, v113
    v_exp_f32 v114, v114
    v_mfma_f32_32x32x16_bf16 v[96:111], a[132:135], a[68:71], v[96:111]
    v_exp_f32 v115, v115
    v_cvt_pk_bf16_f32 v136, v112, v113
    v_exp_f32 v116, v116
    v_exp_f32 v117, v117
    v_mfma_f32_32x32x16_bf16 a[32:47], a[120:123], v[128:131], a[32:47]
    v_cvt_pk_bf16_f32 v137, v114, v115
    v_exp_f32 v118, v118
    v_exp_f32 v119, v119
    v_cvt_pk_bf16_f32 v138, v116, v117
    v_mfma_f32_32x32x16_bf16 a[32:47], a[124:127], v[132:135], a[32:47]
    v_exp_f32 v120, v120
    v_cvt_pk_bf16_f32 v139, v118, v119
    v_exp_f32 v121, v121
    v_exp_f32 v122, v122
    v_smfmac_f32_16x16x64_bf16 a[168:171], v[144:147], v[128:135], v200
    v_exp_f32 v123, v123
    v_cvt_pk_bf16_f32 v140, v120, v121
    v_exp_f32 v124, v124
    v_exp_f32 v125, v125
    v_cvt_pk_bf16_f32 v141, v122, v123
    v_exp_f32 v126, v126
    v_exp_f32 v127, v127
    v_cvt_pk_bf16_f32 v142, v124, v125
    v_cvt_pk_bf16_f32 v143, v126, v127
    v_mfma_f32_32x32x16_bf16 v[112:127], a[128:131], a[72:75], v[48:63]
    v_exp_f32 v96, v96
    v_exp_f32 v97, v97
    v_exp_f32 v98, v98
    v_mfma_f32_32x32x16_bf16 v[112:127], a[132:135], a[76:79], v[112:127]
    v_exp_f32 v99, v99
    v_cvt_pk_bf16_f32 v128, v96, v97
    v_exp_f32 v100, v100
    v_exp_f32 v101, v101
    v_mfma_f32_32x32x16_bf16 a[48:63], a[120:123], v[136:139], a[48:63]
    v_cvt_pk_bf16_f32 v129, v98, v99
    v_exp_f32 v102, v102
    v_exp_f32 v103, v103
    v_cvt_pk_bf16_f32 v130, v100, v101
    v_mfma_f32_32x32x16_bf16 a[48:63], a[124:127], v[140:143], a[48:63]
    v_exp_f32 v104, v104
    v_cvt_pk_bf16_f32 v131, v102, v103
    v_exp_f32 v105, v105
    v_exp_f32 v106, v106
    v_smfmac_f32_16x16x64_bf16 a[172:175], v[144:147], v[136:143], v200
    v_exp_f32 v107, v107
    v_cvt_pk_bf16_f32 v132, v104, v105
    v_exp_f32 v108, v108
    v_exp_f32 v109, v109
    v_cvt_pk_bf16_f32 v133, v106, v107
    v_exp_f32 v110, v110
    v_exp_f32 v111, v111
    v_cvt_pk_bf16_f32 v134, v108, v109
    v_cvt_pk_bf16_f32 v135, v110, v111
    v_mfma_f32_32x32x16_bf16 v[96:111], a[128:131], a[80:83], v[64:79]
    v_exp_f32 v112, v112
    v_exp_f32 v113, v113
    v_exp_f32 v114, v114
    v_mfma_f32_32x32x16_bf16 v[96:111], a[132:135], a[84:87], v[96:111]
    v_exp_f32 v115, v115
    v_cvt_pk_bf16_f32 v136, v112, v113
    v_exp_f32 v116, v116
    v_exp_f32 v117, v117
    v_mfma_f32_32x32x16_bf16 a[0:15], a[136:139], v[128:131], a[0:15]
    buffer_load_dwordx4 a[112:115], v2, s[4:7], s36 offen offset:0 sc1
    v_cvt_pk_bf16_f32 v137, v114, v115
    v_exp_f32 v118, v118
    v_exp_f32 v119, v119
    v_cvt_pk_bf16_f32 v138, v116, v117
    v_mfma_f32_32x32x16_bf16 a[0:15], a[140:143], v[132:135], a[0:15]
    v_exp_f32 v120, v120
    v_cvt_pk_bf16_f32 v139, v118, v119
    v_exp_f32 v121, v121
    v_exp_f32 v122, v122
    v_smfmac_f32_16x16x64_bf16 a[160:163], v[144:147], v[128:135], v200
    buffer_load_dwordx4 a[116:119], v2, s[4:7], s36 offen offset:1024 sc1
    v_exp_f32 v123, v123
    v_cvt_pk_bf16_f32 v140, v120, v121
    v_exp_f32 v124, v124
    v_exp_f32 v125, v125
    v_cvt_pk_bf16_f32 v141, v122, v123
    v_exp_f32 v126, v126
    v_exp_f32 v127, v127
    v_cvt_pk_bf16_f32 v142, v124, v125
    v_cvt_pk_bf16_f32 v143, v126, v127
    v_mfma_f32_32x32x16_bf16 v[112:127], a[128:131], a[88:91], v[80:95]
    v_exp_f32 v96, v96
    v_exp_f32 v97, v97
    v_exp_f32 v98, v98
    v_mfma_f32_32x32x16_bf16 v[112:127], a[132:135], a[92:95], v[112:127]
    v_exp_f32 v99, v99
    v_cvt_pk_bf16_f32 v128, v96, v97
    v_exp_f32 v100, v100
    v_exp_f32 v101, v101
    v_mfma_f32_32x32x16_bf16 a[16:31], a[136:139], v[136:139], a[16:31]
    buffer_load_dwordx4 a[120:123], v2, s[4:7], s36 offen offset:2048 sc1
    v_cvt_pk_bf16_f32 v129, v98, v99
    v_exp_f32 v102, v102
    v_exp_f32 v103, v103
    v_cvt_pk_bf16_f32 v130, v100, v101
    v_mfma_f32_32x32x16_bf16 a[16:31], a[140:143], v[140:143], a[16:31]
    v_exp_f32 v104, v104
    v_cvt_pk_bf16_f32 v131, v102, v103
    v_exp_f32 v105, v105
    v_exp_f32 v106, v106
    v_smfmac_f32_16x16x64_bf16 a[164:167], v[144:147], v[136:143], v200
    buffer_load_dwordx4 a[124:127], v2, s[4:7], s36 offen offset:3072 sc1
    s_add_u32 s36, s36, 4096
    v_exp_f32 v107, v107
    v_cvt_pk_bf16_f32 v132, v104, v105
    v_exp_f32 v108, v108
    v_exp_f32 v109, v109
    v_cvt_pk_bf16_f32 v133, v106, v107
    v_exp_f32 v110, v110
    v_exp_f32 v111, v111
    v_cvt_pk_bf16_f32 v134, v108, v109
    v_cvt_pk_bf16_f32 v135, v110, v111
    s_waitcnt vmcnt(8)
    v_mfma_f32_32x32x16_bf16 v[96:111], a[144:147], a[64:67], v[32:47]
    v_exp_f32 v112, v112
    v_exp_f32 v113, v113
    v_exp_f32 v114, v114
    v_mfma_f32_32x32x16_bf16 v[96:111], a[148:151], a[68:71], v[96:111]
    v_exp_f32 v115, v115
    v_cvt_pk_bf16_f32 v136, v112, v113
    v_exp_f32 v116, v116
    v_exp_f32 v117, v117
    v_mfma_f32_32x32x16_bf16 a[32:47], a[136:139], v[128:131], a[32:47]
    v_cvt_pk_bf16_f32 v137, v114, v115
    v_exp_f32 v118, v118
    v_exp_f32 v119, v119
    v_cvt_pk_bf16_f32 v138, v116, v117
    v_mfma_f32_32x32x16_bf16 a[32:47], a[140:143], v[132:135], a[32:47]
    v_exp_f32 v120, v120
    v_cvt_pk_bf16_f32 v139, v118, v119
    v_exp_f32 v121, v121
    v_exp_f32 v122, v122
    v_smfmac_f32_16x16x64_bf16 a[168:171], v[144:147], v[128:135], v200
    v_exp_f32 v123, v123
    v_cvt_pk_bf16_f32 v140, v120, v121
    v_exp_f32 v124, v124
    v_exp_f32 v125, v125
    v_cvt_pk_bf16_f32 v141, v122, v123
    v_exp_f32 v126, v126
    v_exp_f32 v127, v127
    v_cvt_pk_bf16_f32 v142, v124, v125
    v_cvt_pk_bf16_f32 v143, v126, v127
    v_mfma_f32_32x32x16_bf16 v[112:127], a[144:147], a[72:75], v[48:63]
    v_exp_f32 v96, v96
    v_exp_f32 v97, v97
    v_exp_f32 v98, v98
    v_mfma_f32_32x32x16_bf16 v[112:127], a[148:151], a[76:79], v[112:127]
    v_exp_f32 v99, v99
    v_cvt_pk_bf16_f32 v128, v96, v97
    v_exp_f32 v100, v100
    v_exp_f32 v101, v101
    v_mfma_f32_32x32x16_bf16 a[48:63], a[136:139], v[136:139], a[48:63]
    v_cvt_pk_bf16_f32 v129, v98, v99
    v_exp_f32 v102, v102
    v_exp_f32 v103, v103
    v_cvt_pk_bf16_f32 v130, v100, v101
    v_mfma_f32_32x32x16_bf16 a[48:63], a[140:143], v[140:143], a[48:63]
    v_exp_f32 v104, v104
    v_cvt_pk_bf16_f32 v131, v102, v103
    v_exp_f32 v105, v105
    v_exp_f32 v106, v106
    v_smfmac_f32_16x16x64_bf16 a[172:175], v[144:147], v[136:143], v200
    v_exp_f32 v107, v107
    v_cvt_pk_bf16_f32 v132, v104, v105
    v_exp_f32 v108, v108
    v_exp_f32 v109, v109
    v_cvt_pk_bf16_f32 v133, v106, v107
    v_exp_f32 v110, v110
    v_exp_f32 v111, v111
    v_cvt_pk_bf16_f32 v134, v108, v109
    v_cvt_pk_bf16_f32 v135, v110, v111
    v_mfma_f32_32x32x16_bf16 v[96:111], a[144:147], a[80:83], v[64:79]
    v_exp_f32 v112, v112
    v_exp_f32 v113, v113
    v_exp_f32 v114, v114
    v_mfma_f32_32x32x16_bf16 v[96:111], a[148:151], a[84:87], v[96:111]
    v_exp_f32 v115, v115
    v_cvt_pk_bf16_f32 v136, v112, v113
    v_exp_f32 v116, v116
    v_exp_f32 v117, v117
    v_mfma_f32_32x32x16_bf16 a[0:15], a[152:155], v[128:131], a[0:15]
    buffer_load_dwordx4 a[128:131], v2, s[4:7], s36 offen offset:0 sc1
    v_cvt_pk_bf16_f32 v137, v114, v115
    v_exp_f32 v118, v118
    v_exp_f32 v119, v119
    v_cvt_pk_bf16_f32 v138, v116, v117
    v_mfma_f32_32x32x16_bf16 a[0:15], a[156:159], v[132:135], a[0:15]
    v_exp_f32 v120, v120
    v_cvt_pk_bf16_f32 v139, v118, v119
    v_exp_f32 v121, v121
    v_exp_f32 v122, v122
    v_smfmac_f32_16x16x64_bf16 a[160:163], v[144:147], v[128:135], v200
    buffer_load_dwordx4 a[132:135], v2, s[4:7], s36 offen offset:1024 sc1
    v_exp_f32 v123, v123
    v_cvt_pk_bf16_f32 v140, v120, v121
    v_exp_f32 v124, v124
    v_exp_f32 v125, v125
    v_cvt_pk_bf16_f32 v141, v122, v123
    v_exp_f32 v126, v126
    v_exp_f32 v127, v127
    v_cvt_pk_bf16_f32 v142, v124, v125
    v_cvt_pk_bf16_f32 v143, v126, v127
    v_mfma_f32_32x32x16_bf16 v[112:127], a[144:147], a[88:91], v[80:95]
    v_exp_f32 v96, v96
    v_exp_f32 v97, v97
    v_exp_f32 v98, v98
    v_mfma_f32_32x32x16_bf16 v[112:127], a[148:151], a[92:95], v[112:127]
    v_exp_f32 v99, v99
    v_cvt_pk_bf16_f32 v128, v96, v97
    v_exp_f32 v100, v100
    v_exp_f32 v101, v101
    v_mfma_f32_32x32x16_bf16 a[16:31], a[152:155], v[136:139], a[16:31]
    buffer_load_dwordx4 a[136:139], v2, s[4:7], s36 offen offset:2048 sc1
    v_cvt_pk_bf16_f32 v129, v98, v99
    v_exp_f32 v102, v102
    v_exp_f32 v103, v103
    v_cvt_pk_bf16_f32 v130, v100, v101
    v_mfma_f32_32x32x16_bf16 a[16:31], a[156:159], v[140:143], a[16:31]
    v_exp_f32 v104, v104
    v_cvt_pk_bf16_f32 v131, v102, v103
    v_exp_f32 v105, v105
    v_exp_f32 v106, v106
    v_smfmac_f32_16x16x64_bf16 a[164:167], v[144:147], v[136:143], v200
    buffer_load_dwordx4 a[140:143], v2, s[4:7], s36 offen offset:3072 sc1
    s_add_u32 s36, s36, 4096
    v_exp_f32 v107, v107
    v_cvt_pk_bf16_f32 v132, v104, v105
    v_exp_f32 v108, v108
    v_exp_f32 v109, v109
    v_cvt_pk_bf16_f32 v133, v106, v107
    v_exp_f32 v110, v110
    v_exp_f32 v111, v111
    v_cvt_pk_bf16_f32 v134, v108, v109
    v_cvt_pk_bf16_f32 v135, v110, v111
    s_waitcnt vmcnt(8)
    v_mfma_f32_32x32x16_bf16 v[96:111], a[96:99], a[64:67], v[32:47]
    v_exp_f32 v112, v112
    v_exp_f32 v113, v113
    v_exp_f32 v114, v114
    v_mfma_f32_32x32x16_bf16 v[96:111], a[100:103], a[68:71], v[96:111]
    v_exp_f32 v115, v115
    v_cvt_pk_bf16_f32 v136, v112, v113
    v_exp_f32 v116, v116
    v_exp_f32 v117, v117
    v_mfma_f32_32x32x16_bf16 a[32:47], a[152:155], v[128:131], a[32:47]
    v_cvt_pk_bf16_f32 v137, v114, v115
    v_exp_f32 v118, v118
    v_exp_f32 v119, v119
    v_cvt_pk_bf16_f32 v138, v116, v117
    v_mfma_f32_32x32x16_bf16 a[32:47], a[156:159], v[132:135], a[32:47]
    v_exp_f32 v120, v120
    v_cvt_pk_bf16_f32 v139, v118, v119
    v_exp_f32 v121, v121
    v_exp_f32 v122, v122
    v_smfmac_f32_16x16x64_bf16 a[168:171], v[144:147], v[128:135], v200
    v_exp_f32 v123, v123
    v_cvt_pk_bf16_f32 v140, v120, v121
    v_exp_f32 v124, v124
    v_exp_f32 v125, v125
    v_cvt_pk_bf16_f32 v141, v122, v123
    v_exp_f32 v126, v126
    v_exp_f32 v127, v127
    v_cvt_pk_bf16_f32 v142, v124, v125
    v_cvt_pk_bf16_f32 v143, v126, v127
    s_sub_u32 s35, s35, 1
    s_cmp_lg_u32 s35, 0
    s_cbranch_scc1 L_att_loop
    v_mfma_f32_32x32x16_bf16 a[48:63], a[152:155], v[136:139], a[48:63]
    v_mfma_f32_32x32x16_bf16 a[48:63], a[156:159], v[140:143], a[48:63]
    v_smfmac_f32_16x16x64_bf16 a[172:175], v[144:147], v[136:143], v200
    s_xor_b32 s40, s3, 2
    s_lshl_b32 s41, s40, 13
    s_add_u32 s41, s41, 65536
    v_add_u32 v176, s41, v2
    s_lshl_b32 s41, s40, 10
    s_add_u32 s41, s41, 98304
    v_add_u32 v177, s41, v3
    v_accvgpr_read_b32 v169, a160
    v_accvgpr_read_b32 v180, a161
    v_accvgpr_read_b32 v171, a164
    v_accvgpr_read_b32 v181, a165
    v_accvgpr_read_b32 v173, a168
    v_accvgpr_read_b32 v182, a169
    v_accvgpr_read_b32 v175, a172
    v_accvgpr_read_b32 v183, a173
    v_add_f32 v169, v169, v180
    v_add_f32 v171, v171, v181
    v_add_f32 v173, v173, v182
    v_add_f32 v175, v175, v183
    v_add_f32 v178, v169, v171
    v_add_f32 v178, v178, v173
    v_add_f32 v178, v178, v175
    v_mov_b32 v179, 0x5f800000
    v_cmp_nle_f32 vcc, v178, v179
    s_nop 0
    s_cmp_eq_u64 vcc, 0
    s_cbranch_scc1 L_att_combine
    s_cmp_lg_u32 s29, 0
    s_cbranch_scc1 L_att_combine
    s_mov_b32 s29, 1
    s_mov_b32 s36, s50
    s_mov_b32 s35, 32
    s_waitcnt vmcnt(0)
    v_sub_f32 v168, 0, v168
    v_sub_f32 v170, 0, v170
    v_sub_f32 v172, 0, v172
    v_sub_f32 v174, 0, v174
L_att_maxloop:
    buffer_load_dwordx4 a[96:99], v2, s[4:7], s36 offen offset:0 sc1
    buffer_load_dwordx4 a[100:103], v2, s[4:7], s36 offen offset:1024 sc1
    s_add_u32 s36, s36, 4096
    s_waitcnt vmcnt(0)
    v_mfma_f32_32x32x16_bf16 v[32:47], a[96:99], a[64:67], 0
    v_mfma_f32_32x32x16_bf16 v[32:47], a[100:103], a[68:71], v[32:47]
    v_mfma_f32_32x32x16_bf16 v[48:63], a[96:99], a[72:75], 0
    v_mfma_f32_32x32x16_bf16 v[48:63], a[100:103], a[76:79], v[48:63]
    v_mfma_f32_32x32x16_bf16 v[64:79], a[96:99], a[80:83], 0
    v_mfma_f32_32x32x16_bf16 v[64:79], a[100:103], a[84:87], v[64:79]
    v_mfma_f32_32x32x16_bf16 v[80:95], a[96:99], a[88:91], 0
    v_mfma_f32_32x32x16_bf16 v[80:95], a[100:103], a[92:95], v[80:95]
    s_nop 5
    v_max3_f32 v168, v168, v32, v33
    v_max3_f32 v168, v168, v34, v35
    v_max3_f32 v168, v168, v36, v37
    v_max3_f32 v168, v168, v38, v39
    v_max3_f32 v168, v168, v40, v41
    v_max3_f32 v168, v168, v42, v43
    v_max3_f32 v168, v168, v44, v45
    v_max3_f32 v168, v168, v46, v47
    v_max3_f32 v170, v170, v48, v49
    v_max3_f32 v170, v170, v50, v51
    v_max3_f32 v170, v170, v52, v53
    v_max3_f32 v170, v170, v54, v55
    v_max3_f32 v170, v170, v56, v57
    v_max3_f32 v170, v170, v58, v59
    v_max3_f32 v170, v170, v60, v61
    v_max3_f32 v170, v170, v62, v63
    v_max3_f32 v172, v172, v64, v65
    v_max3_f32 v172, v172, v66, v67
    v_max3_f32 v172, v172, v68, v69
    v_max3_f32 v172, v172, v70, v71
    v_max3_f32 v172, v172, v72, v73
    v_max3_f32 v172, v172, v74, v75
    v_max3_f32 v172, v172, v76, v77
    v_max3_f32 v172, v172, v78, v79
    v_max3_f32 v174, v174, v80, v81
    v_max3_f32 v174, v174, v82, v83
    v_max3_f32 v174, v174, v84, v85
    v_max3_f32 v174, v174, v86, v87
    v_max3_f32 v174, v174, v88, v89
    v_max3_f32 v174, v174, v90, v91
    v_max3_f32 v174, v174, v92, v93
    v_max3_f32 v174, v174, v94, v95
    s_sub_u32 s35, s35, 1
    s_cmp_lg_u32 s35, 0
    s_cbranch_scc1 L_att_maxloop
    s_mov_b32 s36, s50
    buffer_load_dwordx4 a[96:99], v2, s[4:7], s36 offen offset:0 sc1
    buffer_load_dwordx4 a[100:103], v2, s[4:7], s36 offen offset:1024 sc1
    buffer_load_dwordx4 a[104:107], v2, s[4:7], s36 offen offset:2048 sc1
    buffer_load_dwordx4 a[108:111], v2, s[4:7], s36 offen offset:3072 sc1
    s_add_u32 s36, s36, 4096
    buffer_load_dwordx4 a[112:115], v2, s[4:7], s36 offen offset:0 sc1
    buffer_load_dwordx4 a[116:119], v2, s[4:7], s36 offen offset:1024 sc1
    buffer_load_dwordx4 a[120:123], v2, s[4:7], s36 offen offset:2048 sc1
    buffer_load_dwordx4 a[124:127], v2, s[4:7], s36 offen offset:3072 sc1
    s_add_u32 s36, s36, 4096
    buffer_load_dwordx4 a[128:131], v2, s[4:7], s36 offen offset:0 sc1
    buffer_load_dwordx4 a[132:135], v2, s[4:7], s36 offen offset:1024 sc1
    buffer_load_dwordx4 a[136:139], v2, s[4:7], s36 offen offset:2048 sc1
    buffer_load_dwordx4 a[140:143], v2, s[4:7], s36 offen offset:3072 sc1
    s_add_u32 s36, s36, 4096
    v_mov_b32 v136, 0
    v_mov_b32 v137, 0
    v_mov_b32 v138, 0
    v_mov_b32 v139, 0
    v_mov_b32 v140, 0
    v_mov_b32 v141, 0
    v_mov_b32 v142, 0
    v_mov_b32 v143, 0
    v_mfma_f32_32x32x16_bf16 a[0:15], v[136:139], v[136:139], 0
    v_mfma_f32_32x32x16_bf16 a[16:31], v[136:139], v[136:139], 0
    v_mfma_f32_32x32x16_bf16 a[32:47], v[136:139], v[136:139], 0
    v_mfma_f32_32x32x16_bf16 a[48:63], v[136:139], v[136:139], 0
    v_mfma_f32_32x32x16_bf16 a[160:175], v[136:139], v[136:139], 0
    v_mfma_f32_32x32x16_bf16 a[144:159], v[136:139], v[136:139], 0
    s_branch L_att_setmax
L_att_combine:
    ds_write_b128 v176, a[32:35] offset:0
    ds_write_b128 v176, a[36:39] offset:1024
    ds_write_b128 v176, a[40:43] offset:2048
    ds_write_b128 v176, a[44:47] offset:3072
    ds_write_b64 v177, v[172:173] offset:0
    ds_write_b128 v176, a[48:51] offset:4096
    ds_write_b128 v176, a[52:55] offset:5120
    ds_write_b128 v176, a[56:59] offset:6144
    ds_write_b128 v176, a[60:63] offset:7168
    ds_write_b64 v177, v[174:175] offset:512
    s_lshl_b32 s41, s3, 13
    s_add_u32 s41, s41, 65536
    v_add_u32 v176, s41, v2
    s_lshl_b32 s41, s3, 10
    s_add_u32 s41, s41, 98304
    v_add_u32 v177, s41, v3
    v_accvgpr_read_b32 v32, a0
    v_accvgpr_read_b32 v33, a1
    v_accvgpr_read_b32 v34, a2
    v_accvgpr_read_b32 v35, a3
    v_accvgpr_read_b32 v36, a4
    v_accvgpr_read_b32 v37, a5
    v_accvgpr_read_b32 v38, a6
    v_accvgpr_read_b32 v39, a7
    v_accvgpr_read_b32 v40, a8
    v_accvgpr_read_b32 v41, a9
    v_accvgpr_read_b32 v42, a10
    v_accvgpr_read_b32 v43, a11
    v_accvgpr_read_b32 v44, a12
    v_accvgpr_read_b32 v45, a13
    v_accvgpr_read_b32 v46, a14
    v_accvgpr_read_b32 v47, a15
    v_accvgpr_read_b32 v48, a16
    v_accvgpr_read_b32 v49, a17
    v_accvgpr_read_b32 v50, a18
    v_accvgpr_read_b32 v51, a19
    v_accvgpr_read_b32 v52, a20
    v_accvgpr_read_b32 v53, a21
    v_accvgpr_read_b32 v54, a22
    v_accvgpr_read_b32 v55, a23
    v_accvgpr_read_b32 v56, a24
    v_accvgpr_read_b32 v57, a25
    v_accvgpr_read_b32 v58, a26
    v_accvgpr_read_b32 v59, a27
    v_accvgpr_read_b32 v60, a28
    v_accvgpr_read_b32 v61, a29
    v_accvgpr_read_b32 v62, a30
    v_accvgpr_read_b32 v63, a31
    s_waitcnt lgkmcnt(0)
    s_barrier
    ds_read_b64 v[96:97], v177 offset:0
    ds_read_b64 v[98:99], v177 offset:512
    ds_read_b128 v[64:67], v176 offset:0
    ds_read_b128 v[68:71], v176 offset:1024
    ds_read_b128 v[72:75], v176 offset:2048
    ds_read_b128 v[76:79], v176 offset:3072
    ds_read_b128 v[80:83], v176 offset:4096
    ds_read_b128 v[84:87], v176 offset:5120
    ds_read_b128 v[88:91], v176 offset:6144
    ds_read_b128 v[92:95], v176 offset:7168
    s_waitcnt lgkmcnt(8)
    v_min_f32 v108, v168, v96
    v_sub_f32 v104, v108, v168
    v_sub_f32 v106, v108, v96
    v_exp_f32 v104, v104
    v_exp_f32 v106, v106
    s_nop 0
    v_mul_f32 v169, v169, v104
    v_fma_f32 v169, v97, v106, v169
    v_rcp_f32 v108, v169
    s_nop 0
    v_mul_f32 v104, v104, v108
    v_mul_f32 v106, v106, v108
    v_pk_mul_f32 v[32:33], v[32:33], v[104:105] op_sel_hi:[1,0]
    v_pk_mul_f32 v[34:35], v[34:35], v[104:105] op_sel_hi:[1,0]
    v_pk_mul_f32 v[36:37], v[36:37], v[104:105] op_sel_hi:[1,0]
    v_pk_mul_f32 v[38:39], v[38:39], v[104:105] op_sel_hi:[1,0]
    v_pk_mul_f32 v[40:41], v[40:41], v[104:105] op_sel_hi:[1,0]
    v_pk_mul_f32 v[42:43], v[42:43], v[104:105] op_sel_hi:[1,0]
    v_pk_mul_f32 v[44:45], v[44:45], v[104:105] op_sel_hi:[1,0]
    v_pk_mul_f32 v[46:47], v[46:47], v[104:105] op_sel_hi:[1,0]
    s_waitcnt lgkmcnt(4)
    v_pk_fma_f32 v[32:33], v[64:65], v[106:107], v[32:33] op_sel_hi:[1,0,1]
    v_pk_fma_f32 v[34:35], v[66:67], v[106:107], v[34:35] op_sel_hi:[1,0,1]
    v_pk_fma_f32 v[36:37], v[68:69], v[106:107], v[36:37] op_sel_hi:[1,0,1]
    v_pk_fma_f32 v[38:39], v[70:71], v[106:107], v[38:39] op_sel_hi:[1,0,1]
    v_pk_fma_f32 v[40:41], v[72:73], v[106:107], v[40:41] op_sel_hi:[1,0,1]
    v_pk_fma_f32 v[42:43], v[74:75], v[106:107], v[42:43] op_sel_hi:[1,0,1]
    v_pk_fma_f32 v[44:45], v[76:77], v[106:107], v[44:45] op_sel_hi:[1,0,1]
    v_pk_fma_f32 v[46:47], v[78:79], v[106:107], v[46:47] op_sel_hi:[1,0,1]
    v_cvt_pk_bf16_f32 v128, v32, v33
    v_cvt_pk_bf16_f32 v129, v34, v35
    v_cvt_pk_bf16_f32 v130, v36, v37
    v_cvt_pk_bf16_f32 v131, v38, v39
    v_cvt_pk_bf16_f32 v132, v40, v41
    v_cvt_pk_bf16_f32 v133, v42, v43
    v_cvt_pk_bf16_f32 v134, v44, v45
    v_cvt_pk_bf16_f32 v135, v46, v47
    buffer_store_dwordx4 v[128:131], v2, s[4:7], s46 offen offset:0 sc1
    buffer_store_dwordx4 v[132:135], v2, s[4:7], s46 offen offset:1024 sc1
    v_min_f32 v108, v170, v98
    v_sub_f32 v104, v108, v170
    v_sub_f32 v106, v108, v98
    v_exp_f32 v104, v104
    v_exp_f32 v106, v106
    s_nop 0
    v_mul_f32 v171, v171, v104
    v_fma_f32 v171, v99, v106, v171
    v_rcp_f32 v108, v171
    s_nop 0
    v_mul_f32 v104, v104, v108
    v_mul_f32 v106, v106, v108
    v_pk_mul_f32 v[48:49], v[48:49], v[104:105] op_sel_hi:[1,0]
    v_pk_mul_f32 v[50:51], v[50:51], v[104:105] op_sel_hi:[1,0]
    v_pk_mul_f32 v[52:53], v[52:53], v[104:105] op_sel_hi:[1,0]
    v_pk_mul_f32 v[54:55], v[54:55], v[104:105] op_sel_hi:[1,0]
    v_pk_mul_f32 v[56:57], v[56:57], v[104:105] op_sel_hi:[1,0]
    v_pk_mul_f32 v[58:59], v[58:59], v[104:105] op_sel_hi:[1,0]
    v_pk_mul_f32 v[60:61], v[60:61], v[104:105] op_sel_hi:[1,0]
    v_pk_mul_f32 v[62:63], v[62:63], v[104:105] op_sel_hi:[1,0]
    s_waitcnt lgkmcnt(0)
    v_pk_fma_f32 v[48:49], v[80:81], v[106:107], v[48:49] op_sel_hi:[1,0,1]
    v_pk_fma_f32 v[50:51], v[82:83], v[106:107], v[50:51] op_sel_hi:[1,0,1]
    v_pk_fma_f32 v[52:53], v[84:85], v[106:107], v[52:53] op_sel_hi:[1,0,1]
    v_pk_fma_f32 v[54:55], v[86:87], v[106:107], v[54:55] op_sel_hi:[1,0,1]
    v_pk_fma_f32 v[56:57], v[88:89], v[106:107], v[56:57] op_sel_hi:[1,0,1]
    v_pk_fma_f32 v[58:59], v[90:91], v[106:107], v[58:59] op_sel_hi:[1,0,1]
    v_pk_fma_f32 v[60:61], v[92:93], v[106:107], v[60:61] op_sel_hi:[1,0,1]
    v_pk_fma_f32 v[62:63], v[94:95], v[106:107], v[62:63] op_sel_hi:[1,0,1]
    v_cvt_pk_bf16_f32 v136, v48, v49
    v_cvt_pk_bf16_f32 v137, v50, v51
    v_cvt_pk_bf16_f32 v138, v52, v53
    v_cvt_pk_bf16_f32 v139, v54, v55
    v_cvt_pk_bf16_f32 v140, v56, v57
    v_cvt_pk_bf16_f32 v141, v58, v59
    v_cvt_pk_bf16_f32 v142, v60, v61
    v_cvt_pk_bf16_f32 v143, v62, v63
    buffer_store_dwordx4 v[136:139], v2, s[4:7], s47 offen offset:0 sc1
    buffer_store_dwordx4 v[140:143], v2, s[4:7], s47 offen offset:1024 sc1
    s_waitcnt vmcnt(0)
    s_barrier
    s_cmp_lg_u32 s3, 0
    s_cbranch_scc1 L_pub10
    v_mov_b32 v4, s34
    s_mov_b64 exec, 1
    buffer_store_dword v4, v27, s[4:7], s60 offen sc1
    s_mov_b64 exec, -1
L_pub10:
    s_mov_b32 s20, s92
    s_mov_b32 s21, s93
    s_call_b64 s[30:31], L_usemap
    s_mov_b32 s52, 65536
    s_call_b64 s[30:31], L_grp2
    s_and_b32 s56, s60, 0xfffff0ff
    s_cmp_lg_u32 s3, 0
    s_cbranch_scc1 L_wd11
    s_mov_b32 s57, 15
    s_call_b64 s[48:49], L_poll
L_wd11:
    s_barrier
    s_add_u32 s34, s34, 1
    s_lshl_b32 s36, s22, 16
    s_add_u32 s36, s36, s33
    s_add_u32 s36, s36, 12582912
    s_call_b64 s[30:31], L_x0
    s_mov_b64 vcc, 0
    s_call_b64 s[30:31], L_passF
    s_call_b64 s[30:31], L_resid
    s_cmp_lg_u32 s39, 0
    s_cbranch_scc1 L_final
    s_mov_b32 s33, 0
    s_mov_b32 s39, 1
    s_add_u32 s44, s33, 0
    s_add_u32 s45, s33, 21233664
    s_call_b64 s[30:31], L_xout
    s_waitcnt vmcnt(0)
    s_barrier
    s_cmp_lg_u32 s3, 0
    s_cbranch_scc1 L_pub12
    v_mov_b32 v4, s34
    s_mov_b64 exec, 1
    buffer_store_dword v4, v27, s[4:7], s60 offen sc1
    s_mov_b64 exec, -1
L_pub12:
    s_mov_b32 s20, s90
    s_mov_b32 s21, s91
    s_call_b64 s[30:31], L_usemap
    s_mov_b32 s8, s86
    s_mov_b32 s9, s87
    s_mov_b32 s10, 268435456
    s_lshl_b32 s24, s91, 17
    s_add_u32 s24, s24, 35651584
    s_mov_b32 s25, 8192
    v_mov_b32 v6, v20
    v_mov_b32 v7, v20
    s_and_b32 s56, s60, 0xfffff0ff
    s_mov_b32 s52, 0
    s_call_b64 s[30:31], L_grp2
    buffer_load_dword v18, v17, s[4:7], s56 offen sc1
    s_mov_b32 s52, 65536
    s_call_b64 s[30:31], L_grp2
    s_cmp_lg_u32 s3, 0
    s_cbranch_scc1 L_rw13
    s_waitcnt vmcnt(16)
    v_cmp_le_u32 s[54:55], s34, v18
    s_nop 0
    s_cmp_eq_u64 s[54:55], exec
    s_cbranch_scc1 L_rw13
    s_mov_b32 s57, 15
    s_call_b64 s[48:49], L_poll
L_rw13:
    s_barrier
    s_add_u32 s34, s34, 1
    s_branch L_pair
L_final:
    s_mov_b32 s16, s82
    s_mov_b32 s17, s83
    s_mov_b32 s18, 4194304
    s_mul_i32 s42, s3, 4608
    s_add_u32 s42, s42, 135168
    v_and_b32 v132, 31, v1
    v_mul_u32_u24 v132, 144, v132
    v_lshrrev_b32 v133, 5, v1
    v_lshl_add_u32 v132, v133, 4, v132
    v_add_u32 v132, s42, v132
    v_lshrrev_b32 v133, 3, v1
    v_and_b32 v134, 7, v1
    v_mul_u32_u24 v135, 144, v133
    v_lshl_add_u32 v135, v134, 4, v135
    v_add_u32 v135, s42, v135
    v_lshlrev_b32 v133, 11, v133
    v_lshl_add_u32 v133, v134, 4, v133
    s_lshl_b32 s40, s22, 16
    s_lshl_b32 s41, s21, 7
    s_add_u32 s40, s40, s41
    v_permlane32_swap_b32 v240, v242
    v_permlane32_swap_b32 v241, v243
    ds_write_b128 v132, v[240:243] offset:0
    v_permlane32_swap_b32 v244, v246
    v_permlane32_swap_b32 v245, v247
    ds_write_b128 v132, v[244:247] offset:32
    v_permlane32_swap_b32 v248, v250
    v_permlane32_swap_b32 v249, v251
    ds_write_b128 v132, v[248:251] offset:64
    v_permlane32_swap_b32 v252, v254
    v_permlane32_swap_b32 v253, v255
    ds_write_b128 v132, v[252:255] offset:96
    s_waitcnt lgkmcnt(0)
    ds_read_b128 v[140:143], v135 offset:0
    ds_read_b128 v[144:147], v135 offset:1152
    ds_read_b128 v[148:151], v135 offset:2304
    ds_read_b128 v[152:155], v135 offset:3456
    s_waitcnt lgkmcnt(3)
    buffer_store_dwordx4 v[140:143], v133, s[16:19], s40 offen sc1
    s_add_u32 s40, s40, 16384
    s_waitcnt lgkmcnt(2)
    buffer_store_dwordx4 v[144:147], v133, s[16:19], s40 offen sc1
    s_add_u32 s40, s40, 16384
    s_waitcnt lgkmcnt(1)
    buffer_store_dwordx4 v[148:151], v133, s[16:19], s40 offen sc1
    s_add_u32 s40, s40, 16384
    s_waitcnt lgkmcnt(0)
    buffer_store_dwordx4 v[152:155], v133, s[16:19], s40 offen sc1
    s_add_u32 s40, s40, 16384
L_end:
    s_endpgm
L_passF:
    s_barrier
    ds_read_b128 v[64:67], v2 offset:0
    ds_read_b128 v[68:71], v2 offset:1024
    ds_read_b128 v[72:75], v2 offset:2048
    ds_read_b128 v[76:79], v2 offset:3072
    ds_read_b128 v[80:83], v2 offset:4096
    ds_read_b128 v[84:87], v2 offset:5120
    s_waitcnt vmcnt(7) lgkmcnt(4)
    v_mfma_f32_32x32x16_bf16 v[32:47], v[64:67], a[0:3], 0
    ds_read_b128 v[88:91], v2 offset:6144
    buffer_load_dwordx4 a[32:35], v2, s[4:7], s36 offen offset:0 sc1
    v_mfma_f32_32x32x16_bf16 v[48:63], v[68:71], a[0:3], 0
    ds_read_b128 v[92:95], v2 offset:7168
    buffer_load_dwordx4 a[36:39], v2, s[4:7], s36 offen offset:1024 sc1
    s_waitcnt vmcnt(8) lgkmcnt(4)
    v_mfma_f32_32x32x16_bf16 v[32:47], v[72:75], a[4:7], v[32:47]
    ds_read_b128 v[64:67], v2 offset:8192
    buffer_load_dwordx4 a[40:43], v2, s[4:7], s36 offen offset:2048 sc1
    v_mfma_f32_32x32x16_bf16 v[48:63], v[76:79], a[4:7], v[48:63]
    ds_read_b128 v[68:71], v2 offset:9216
    buffer_load_dwordx4 a[44:47], v2, s[4:7], s36 offen offset:3072 sc1
    s_add_u32 s36, s36, 4096
    s_waitcnt vmcnt(9) lgkmcnt(4)
    v_mfma_f32_32x32x16_bf16 v[32:47], v[80:83], a[8:11], v[32:47]
    ds_read_b128 v[72:75], v2 offset:10240
    buffer_load_dwordx4 a[48:51], v2, s[4:7], s36 offen offset:0 sc1
    v_mfma_f32_32x32x16_bf16 v[48:63], v[84:87], a[8:11], v[48:63]
    ds_read_b128 v[76:79], v2 offset:11264
    buffer_load_dwordx4 a[52:55], v2, s[4:7], s36 offen offset:1024 sc1
    s_waitcnt vmcnt(10) lgkmcnt(4)
    v_mfma_f32_32x32x16_bf16 v[32:47], v[88:91], a[12:15], v[32:47]
    ds_read_b128 v[80:83], v2 offset:12288
    buffer_load_dwordx4 a[56:59], v2, s[4:7], s36 offen offset:2048 sc1
    v_mfma_f32_32x32x16_bf16 v[48:63], v[92:95], a[12:15], v[48:63]
    ds_read_b128 v[84:87], v2 offset:13312
    s_waitcnt vmcnt(10) lgkmcnt(4)
    v_mfma_f32_32x32x16_bf16 v[32:47], v[64:67], a[16:19], v[32:47]
    ds_read_b128 v[88:91], v2 offset:14336
    buffer_load_dwordx4 a[60:63], v2, s[4:7], s36 offen offset:3072 sc1
    s_add_u32 s36, s36, 4096
    v_mfma_f32_32x32x16_bf16 v[48:63], v[68:71], a[16:19], v[48:63]
    ds_read_b128 v[92:95], v2 offset:15360
    s_waitcnt vmcnt(10) lgkmcnt(4)
    v_mfma_f32_32x32x16_bf16 v[32:47], v[72:75], a[20:23], v[32:47]
    ds_read_b128 v[64:67], v2 offset:16384
    buffer_load_dwordx4 a[64:67], v2, s[4:7], s36 offen offset:0 sc1
    v_mfma_f32_32x32x16_bf16 v[48:63], v[76:79], a[20:23], v[48:63]
    ds_read_b128 v[68:71], v2 offset:17408
    s_waitcnt vmcnt(10) lgkmcnt(4)
    v_mfma_f32_32x32x16_bf16 v[32:47], v[80:83], a[24:27], v[32:47]
    ds_read_b128 v[72:75], v2 offset:18432
    buffer_load_dwordx4 a[68:71], v2, s[4:7], s36 offen offset:1024 sc1
    v_mfma_f32_32x32x16_bf16 v[48:63], v[84:87], a[24:27], v[48:63]
    ds_read_b128 v[76:79], v2 offset:19456
    s_waitcnt vmcnt(10) lgkmcnt(4)
    v_mfma_f32_32x32x16_bf16 v[32:47], v[88:91], a[28:31], v[32:47]
    ds_read_b128 v[80:83], v2 offset:20480
    buffer_load_dwordx4 a[72:75], v2, s[4:7], s36 offen offset:2048 sc1
    v_mfma_f32_32x32x16_bf16 v[48:63], v[92:95], a[28:31], v[48:63]
    ds_read_b128 v[84:87], v2 offset:21504
    s_waitcnt vmcnt(10) lgkmcnt(4)
    v_mfma_f32_32x32x16_bf16 v[32:47], v[64:67], a[32:35], v[32:47]
    ds_read_b128 v[88:91], v2 offset:22528
    buffer_load_dwordx4 a[76:79], v2, s[4:7], s36 offen offset:3072 sc1
    s_add_u32 s36, s36, 4096
    v_mfma_f32_32x32x16_bf16 v[48:63], v[68:71], a[32:35], v[48:63]
    ds_read_b128 v[92:95], v2 offset:23552
    s_waitcnt vmcnt(10) lgkmcnt(4)
    v_mfma_f32_32x32x16_bf16 v[32:47], v[72:75], a[36:39], v[32:47]
    ds_read_b128 v[64:67], v2 offset:24576
    buffer_load_dwordx4 a[80:83], v2, s[4:7], s36 offen offset:0 sc1
    v_mfma_f32_32x32x16_bf16 v[48:63], v[76:79], a[36:39], v[48:63]
    ds_read_b128 v[68:71], v2 offset:25600
    s_waitcnt vmcnt(10) lgkmcnt(4)
    v_mfma_f32_32x32x16_bf16 v[32:47], v[80:83], a[40:43], v[32:47]
    ds_read_b128 v[72:75], v2 offset:26624
    buffer_load_dwordx4 a[84:87], v2, s[4:7], s36 offen offset:1024 sc1
    v_mfma_f32_32x32x16_bf16 v[48:63], v[84:87], a[40:43], v[48:63]
    ds_read_b128 v[76:79], v2 offset:27648
    s_waitcnt vmcnt(10) lgkmcnt(4)
    v_mfma_f32_32x32x16_bf16 v[32:47], v[88:91], a[44:47], v[32:47]
    ds_read_b128 v[80:83], v2 offset:28672
    buffer_load_dwordx4 a[88:91], v2, s[4:7], s36 offen offset:2048 sc1
    v_mfma_f32_32x32x16_bf16 v[48:63], v[92:95], a[44:47], v[48:63]
    ds_read_b128 v[84:87], v2 offset:29696
    s_waitcnt vmcnt(10) lgkmcnt(4)
    v_mfma_f32_32x32x16_bf16 v[32:47], v[64:67], a[48:51], v[32:47]
    ds_read_b128 v[88:91], v2 offset:30720
    buffer_load_dwordx4 a[92:95], v2, s[4:7], s36 offen offset:3072 sc1
    s_add_u32 s36, s36, 4096
    v_mfma_f32_32x32x16_bf16 v[48:63], v[68:71], a[48:51], v[48:63]
    ds_read_b128 v[92:95], v2 offset:31744
    s_waitcnt vmcnt(10) lgkmcnt(4)
    v_mfma_f32_32x32x16_bf16 v[32:47], v[72:75], a[52:55], v[32:47]
    ds_read_b128 v[64:67], v2 offset:32768
    buffer_load_dwordx4 a[96:99], v2, s[4:7], s36 offen offset:0 sc1
    v_mfma_f32_32x32x16_bf16 v[48:63], v[76:79], a[52:55], v[48:63]
    ds_read_b128 v[68:71], v2 offset:33792
    s_waitcnt vmcnt(10) lgkmcnt(4)
    v_mfma_f32_32x32x16_bf16 v[32:47], v[80:83], a[56:59], v[32:47]
    ds_read_b128 v[72:75], v2 offset:34816
    buffer_load_dwordx4 a[100:103], v2, s[4:7], s36 offen offset:1024 sc1
    v_mfma_f32_32x32x16_bf16 v[48:63], v[84:87], a[56:59], v[48:63]
    ds_read_b128 v[76:79], v2 offset:35840
    s_waitcnt vmcnt(10) lgkmcnt(4)
    v_mfma_f32_32x32x16_bf16 v[32:47], v[88:91], a[60:63], v[32:47]
    ds_read_b128 v[80:83], v2 offset:36864
    buffer_load_dwordx4 a[104:107], v2, s[4:7], s36 offen offset:2048 sc1
    v_mfma_f32_32x32x16_bf16 v[48:63], v[92:95], a[60:63], v[48:63]
    ds_read_b128 v[84:87], v2 offset:37888
    s_waitcnt vmcnt(10) lgkmcnt(4)
    v_mfma_f32_32x32x16_bf16 v[32:47], v[64:67], a[64:67], v[32:47]
    ds_read_b128 v[88:91], v2 offset:38912
    buffer_load_dwordx4 a[108:111], v2, s[4:7], s36 offen offset:3072 sc1
    s_add_u32 s36, s36, 4096
    v_mfma_f32_32x32x16_bf16 v[48:63], v[68:71], a[64:67], v[48:63]
    ds_read_b128 v[92:95], v2 offset:39936
    s_waitcnt vmcnt(10) lgkmcnt(4)
    v_mfma_f32_32x32x16_bf16 v[32:47], v[72:75], a[68:71], v[32:47]
    ds_read_b128 v[64:67], v2 offset:40960
    buffer_load_dwordx4 a[112:115], v2, s[4:7], s36 offen offset:0 sc1
    v_mfma_f32_32x32x16_bf16 v[48:63], v[76:79], a[68:71], v[48:63]
    ds_read_b128 v[68:71], v2 offset:41984
    s_waitcnt vmcnt(10) lgkmcnt(4)
    v_mfma_f32_32x32x16_bf16 v[32:47], v[80:83], a[72:75], v[32:47]
    ds_read_b128 v[72:75], v2 offset:43008
    buffer_load_dwordx4 a[116:119], v2, s[4:7], s36 offen offset:1024 sc1
    v_mfma_f32_32x32x16_bf16 v[48:63], v[84:87], a[72:75], v[48:63]
    ds_read_b128 v[76:79], v2 offset:44032
    s_waitcnt vmcnt(10) lgkmcnt(4)
    v_mfma_f32_32x32x16_bf16 v[32:47], v[88:91], a[76:79], v[32:47]
    ds_read_b128 v[80:83], v2 offset:45056
    buffer_load_dwordx4 a[120:123], v2, s[4:7], s36 offen offset:2048 sc1
    v_mfma_f32_32x32x16_bf16 v[48:63], v[92:95], a[76:79], v[48:63]
    ds_read_b128 v[84:87], v2 offset:46080
    s_waitcnt vmcnt(10) lgkmcnt(4)
    v_mfma_f32_32x32x16_bf16 v[32:47], v[64:67], a[80:83], v[32:47]
    ds_read_b128 v[88:91], v2 offset:47104
    buffer_load_dwordx4 a[124:127], v2, s[4:7], s36 offen offset:3072 sc1
    s_add_u32 s36, s36, 4096
    v_mfma_f32_32x32x16_bf16 v[48:63], v[68:71], a[80:83], v[48:63]
    ds_read_b128 v[92:95], v2 offset:48128
    s_waitcnt vmcnt(10) lgkmcnt(4)
    v_mfma_f32_32x32x16_bf16 v[32:47], v[72:75], a[84:87], v[32:47]
    ds_read_b128 v[64:67], v2 offset:49152
    buffer_load_dwordx4 a[128:131], v2, s[4:7], s36 offen offset:0 sc1
    v_mfma_f32_32x32x16_bf16 v[48:63], v[76:79], a[84:87], v[48:63]
    ds_read_b128 v[68:71], v2 offset:50176
    s_waitcnt vmcnt(10) lgkmcnt(4)
    v_mfma_f32_32x32x16_bf16 v[32:47], v[80:83], a[88:91], v[32:47]
    ds_read_b128 v[72:75], v2 offset:51200
    buffer_load_dwordx4 a[132:135], v2, s[4:7], s36 offen offset:1024 sc1
    v_mfma_f32_32x32x16_bf16 v[48:63], v[84:87], a[88:91], v[48:63]
    ds_read_b128 v[76:79], v2 offset:52224
    s_waitcnt vmcnt(10) lgkmcnt(4)
    v_mfma_f32_32x32x16_bf16 v[32:47], v[88:91], a[92:95], v[32:47]
    ds_read_b128 v[80:83], v2 offset:53248
    buffer_load_dwordx4 a[136:139], v2, s[4:7], s36 offen offset:2048 sc1
    v_mfma_f32_32x32x16_bf16 v[48:63], v[92:95], a[92:95], v[48:63]
    ds_read_b128 v[84:87], v2 offset:54272
    s_waitcnt vmcnt(10) lgkmcnt(4)
    v_mfma_f32_32x32x16_bf16 v[32:47], v[64:67], a[96:99], v[32:47]
    ds_read_b128 v[88:91], v2 offset:55296
    buffer_load_dwordx4 a[140:143], v2, s[4:7], s36 offen offset:3072 sc1
    s_add_u32 s36, s36, 4096
    v_mfma_f32_32x32x16_bf16 v[48:63], v[68:71], a[96:99], v[48:63]
    ds_read_b128 v[92:95], v2 offset:56320
    s_waitcnt vmcnt(10) lgkmcnt(4)
    v_mfma_f32_32x32x16_bf16 v[32:47], v[72:75], a[100:103], v[32:47]
    ds_read_b128 v[64:67], v2 offset:57344
    buffer_load_dwordx4 a[144:147], v2, s[4:7], s36 offen offset:0 sc1
    v_mfma_f32_32x32x16_bf16 v[48:63], v[76:79], a[100:103], v[48:63]
    ds_read_b128 v[68:71], v2 offset:58368
    s_waitcnt vmcnt(10) lgkmcnt(4)
    v_mfma_f32_32x32x16_bf16 v[32:47], v[80:83], a[104:107], v[32:47]
    ds_read_b128 v[72:75], v2 offset:59392
    buffer_load_dwordx4 a[148:151], v2, s[4:7], s36 offen offset:1024 sc1
    v_mfma_f32_32x32x16_bf16 v[48:63], v[84:87], a[104:107], v[48:63]
    ds_read_b128 v[76:79], v2 offset:60416
    s_waitcnt vmcnt(10) lgkmcnt(4)
    v_mfma_f32_32x32x16_bf16 v[32:47], v[88:91], a[108:111], v[32:47]
    ds_read_b128 v[80:83], v2 offset:61440
    buffer_load_dwordx4 a[152:155], v2, s[4:7], s36 offen offset:2048 sc1
    v_mfma_f32_32x32x16_bf16 v[48:63], v[92:95], a[108:111], v[48:63]
    ds_read_b128 v[84:87], v2 offset:62464
    s_waitcnt vmcnt(10) lgkmcnt(4)
    v_mfma_f32_32x32x16_bf16 v[32:47], v[64:67], a[112:115], v[32:47]
    ds_read_b128 v[88:91], v2 offset:63488
    buffer_load_dwordx4 a[156:159], v2, s[4:7], s36 offen offset:3072 sc1
    s_add_u32 s36, s36, 4096
    v_mfma_f32_32x32x16_bf16 v[48:63], v[68:71], a[112:115], v[48:63]
    ds_read_b128 v[92:95], v2 offset:64512
    s_barrier
    s_waitcnt vmcnt(10) lgkmcnt(4)
    v_mfma_f32_32x32x16_bf16 v[32:47], v[72:75], a[116:119], v[32:47]
    ds_read_b128 v[64:67], v15 offset:0
    buffer_load_dwordx4 a[160:163], v2, s[4:7], s36 offen offset:0 sc1
    v_mfma_f32_32x32x16_bf16 v[48:63], v[76:79], a[116:119], v[48:63]
    ds_read_b128 v[68:71], v15 offset:1024
    s_cbranch_vccz L_pfF29
    s_add_u32 m0, s28, 0
    s_nop 0
    buffer_load_dwordx4 v8, s[12:15], s26 offen sc1 lds
L_pfF29:
    s_waitcnt vmcnt(10) lgkmcnt(4)
    v_mfma_f32_32x32x16_bf16 v[32:47], v[80:83], a[120:123], v[32:47]
    ds_read_b128 v[72:75], v15 offset:2048
    buffer_load_dwordx4 a[164:167], v2, s[4:7], s36 offen offset:1024 sc1
    v_mfma_f32_32x32x16_bf16 v[48:63], v[84:87], a[120:123], v[48:63]
    ds_read_b128 v[76:79], v15 offset:3072
    s_waitcnt vmcnt(10) lgkmcnt(4)
    v_mfma_f32_32x32x16_bf16 v[32:47], v[88:91], a[124:127], v[32:47]
    ds_read_b128 v[80:83], v15 offset:4096
    buffer_load_dwordx4 a[168:171], v2, s[4:7], s36 offen offset:2048 sc1
    v_mfma_f32_32x32x16_bf16 v[48:63], v[92:95], a[124:127], v[48:63]
    ds_read_b128 v[84:87], v15 offset:5120
    s_cbranch_vccz L_pfF31
    buffer_load_dwordx4 v9, s[12:15], s26 offen offset:1024 sc1 lds
    s_add_u32 s26, s26, s27
L_pfF31:
    s_waitcnt vmcnt(10) lgkmcnt(4)
    v_mfma_f32_32x32x16_bf16 v[32:47], v[64:67], a[128:131], v[32:47]
    ds_read_b128 v[88:91], v15 offset:6144
    buffer_load_dwordx4 a[172:175], v2, s[4:7], s36 offen offset:3072 sc1
    s_add_u32 s36, s36, 4096
    v_mfma_f32_32x32x16_bf16 v[48:63], v[68:71], a[128:131], v[48:63]
    ds_read_b128 v[92:95], v15 offset:7168
    s_waitcnt vmcnt(10) lgkmcnt(4)
    v_mfma_f32_32x32x16_bf16 v[32:47], v[72:75], a[132:135], v[32:47]
    ds_read_b128 v[64:67], v15 offset:8192
    buffer_load_dwordx4 a[176:179], v2, s[4:7], s36 offen offset:0 sc1
    v_mfma_f32_32x32x16_bf16 v[48:63], v[76:79], a[132:135], v[48:63]
    ds_read_b128 v[68:71], v15 offset:9216
    s_cbranch_vccz L_pfF33
    s_add_u32 m0, s28, 8192
    s_nop 0
    buffer_load_dwordx4 v8, s[12:15], s26 offen sc1 lds
L_pfF33:
    s_waitcnt vmcnt(10) lgkmcnt(4)
    v_mfma_f32_32x32x16_bf16 v[32:47], v[80:83], a[136:139], v[32:47]
    ds_read_b128 v[72:75], v15 offset:10240
    buffer_load_dwordx4 a[180:183], v2, s[4:7], s36 offen offset:1024 sc1
    v_mfma_f32_32x32x16_bf16 v[48:63], v[84:87], a[136:139], v[48:63]
    ds_read_b128 v[76:79], v15 offset:11264
    s_waitcnt vmcnt(10) lgkmcnt(4)
    v_mfma_f32_32x32x16_bf16 v[32:47], v[88:91], a[140:143], v[32:47]
    ds_read_b128 v[80:83], v15 offset:12288
    buffer_load_dwordx4 a[184:187], v2, s[4:7], s36 offen offset:2048 sc1
    v_mfma_f32_32x32x16_bf16 v[48:63], v[92:95], a[140:143], v[48:63]
    ds_read_b128 v[84:87], v15 offset:13312
    s_cbranch_vccz L_pfF35
    buffer_load_dwordx4 v9, s[12:15], s26 offen offset:1024 sc1 lds
    s_add_u32 s26, s26, s27
L_pfF35:
    s_waitcnt vmcnt(10) lgkmcnt(4)
    v_mfma_f32_32x32x16_bf16 v[32:47], v[64:67], a[144:147], v[32:47]
    ds_read_b128 v[88:91], v15 offset:14336
    buffer_load_dwordx4 a[188:191], v2, s[4:7], s36 offen offset:3072 sc1
    s_add_u32 s36, s36, 4096
    v_mfma_f32_32x32x16_bf16 v[48:63], v[68:71], a[144:147], v[48:63]
    ds_read_b128 v[92:95], v15 offset:15360
    s_waitcnt vmcnt(10) lgkmcnt(4)
    v_mfma_f32_32x32x16_bf16 v[32:47], v[72:75], a[148:151], v[32:47]
    ds_read_b128 v[64:67], v15 offset:16384
    buffer_load_dwordx4 a[192:195], v2, s[4:7], s36 offen offset:0 sc1
    v_mfma_f32_32x32x16_bf16 v[48:63], v[76:79], a[148:151], v[48:63]
    ds_read_b128 v[68:71], v15 offset:17408
    s_cbranch_vccz L_pfF37
    s_add_u32 m0, s28, 16384
    s_nop 0
    buffer_load_dwordx4 v8, s[12:15], s26 offen sc1 lds
L_pfF37:
    s_waitcnt vmcnt(10) lgkmcnt(4)
    v_mfma_f32_32x32x16_bf16 v[32:47], v[80:83], a[152:155], v[32:47]
    ds_read_b128 v[72:75], v15 offset:18432
    buffer_load_dwordx4 a[196:199], v2, s[4:7], s36 offen offset:1024 sc1
    v_mfma_f32_32x32x16_bf16 v[48:63], v[84:87], a[152:155], v[48:63]
    ds_read_b128 v[76:79], v15 offset:19456
    s_waitcnt vmcnt(10) lgkmcnt(4)
    v_mfma_f32_32x32x16_bf16 v[32:47], v[88:91], a[156:159], v[32:47]
    ds_read_b128 v[80:83], v15 offset:20480
    buffer_load_dwordx4 a[200:203], v2, s[4:7], s36 offen offset:2048 sc1
    v_mfma_f32_32x32x16_bf16 v[48:63], v[92:95], a[156:159], v[48:63]
    ds_read_b128 v[84:87], v15 offset:21504
    s_cbranch_vccz L_pfF39
    buffer_load_dwordx4 v9, s[12:15], s26 offen offset:1024 sc1 lds
    s_add_u32 s26, s26, s27
L_pfF39:
    s_waitcnt vmcnt(10) lgkmcnt(4)
    v_mfma_f32_32x32x16_bf16 v[32:47], v[64:67], a[160:163], v[32:47]
    ds_read_b128 v[88:91], v15 offset:22528
    buffer_load_dwordx4 a[204:207], v2, s[4:7], s36 offen offset:3072 sc1
    s_add_u32 s36, s36, 4096
    v_mfma_f32_32x32x16_bf16 v[48:63], v[68:71], a[160:163], v[48:63]
    ds_read_b128 v[92:95], v15 offset:23552
    s_waitcnt vmcnt(10) lgkmcnt(4)
    v_mfma_f32_32x32x16_bf16 v[32:47], v[72:75], a[164:167], v[32:47]
    ds_read_b128 v[64:67], v15 offset:24576
    buffer_load_dwordx4 a[208:211], v2, s[4:7], s36 offen offset:0 sc1
    v_mfma_f32_32x32x16_bf16 v[48:63], v[76:79], a[164:167], v[48:63]
    ds_read_b128 v[68:71], v15 offset:25600
    s_cbranch_vccz L_pfF41
    s_add_u32 m0, s28, 24576
    s_nop 0
    buffer_load_dwordx4 v8, s[12:15], s26 offen sc1 lds
L_pfF41:
    s_waitcnt vmcnt(10) lgkmcnt(4)
    v_mfma_f32_32x32x16_bf16 v[32:47], v[80:83], a[168:171], v[32:47]
    ds_read_b128 v[72:75], v15 offset:26624
    buffer_load_dwordx4 a[212:215], v2, s[4:7], s36 offen offset:1024 sc1
    v_mfma_f32_32x32x16_bf16 v[48:63], v[84:87], a[168:171], v[48:63]
    ds_read_b128 v[76:79], v15 offset:27648
    s_waitcnt vmcnt(10) lgkmcnt(4)
    v_mfma_f32_32x32x16_bf16 v[32:47], v[88:91], a[172:175], v[32:47]
    ds_read_b128 v[80:83], v15 offset:28672
    buffer_load_dwordx4 a[216:219], v2, s[4:7], s36 offen offset:2048 sc1
    v_mfma_f32_32x32x16_bf16 v[48:63], v[92:95], a[172:175], v[48:63]
    ds_read_b128 v[84:87], v15 offset:29696
    s_cbranch_vccz L_pfF43
    buffer_load_dwordx4 v9, s[12:15], s26 offen offset:1024 sc1 lds
    s_add_u32 s26, s26, s27
L_pfF43:
    s_waitcnt vmcnt(10) lgkmcnt(4)
    v_mfma_f32_32x32x16_bf16 v[32:47], v[64:67], a[176:179], v[32:47]
    ds_read_b128 v[88:91], v15 offset:30720
    buffer_load_dwordx4 a[220:223], v2, s[4:7], s36 offen offset:3072 sc1
    s_add_u32 s36, s36, 4096
    v_mfma_f32_32x32x16_bf16 v[48:63], v[68:71], a[176:179], v[48:63]
    ds_read_b128 v[92:95], v15 offset:31744
    s_barrier
    s_waitcnt vmcnt(10) lgkmcnt(4)
    v_mfma_f32_32x32x16_bf16 v[32:47], v[72:75], a[180:183], v[32:47]
    ds_read_b128 v[64:67], v15 offset:32768
    buffer_load_dwordx4 a[224:227], v2, s[4:7], s36 offen offset:0 sc1
    v_mfma_f32_32x32x16_bf16 v[48:63], v[76:79], a[180:183], v[48:63]
    ds_read_b128 v[68:71], v15 offset:33792
    s_cbranch_vccz L_pfF45
    s_add_u32 m0, s28, 32768
    s_nop 0
    buffer_load_dwordx4 v8, s[12:15], s26 offen sc1 lds
L_pfF45:
    s_waitcnt vmcnt(10) lgkmcnt(4)
    v_mfma_f32_32x32x16_bf16 v[32:47], v[80:83], a[184:187], v[32:47]
    ds_read_b128 v[72:75], v15 offset:34816
    buffer_load_dwordx4 a[228:231], v2, s[4:7], s36 offen offset:1024 sc1
    v_mfma_f32_32x32x16_bf16 v[48:63], v[84:87], a[184:187], v[48:63]
    ds_read_b128 v[76:79], v15 offset:35840
    s_waitcnt vmcnt(10) lgkmcnt(4)
    v_mfma_f32_32x32x16_bf16 v[32:47], v[88:91], a[188:191], v[32:47]
    ds_read_b128 v[80:83], v15 offset:36864
    buffer_load_dwordx4 a[232:235], v2, s[4:7], s36 offen offset:2048 sc1
    v_mfma_f32_32x32x16_bf16 v[48:63], v[92:95], a[188:191], v[48:63]
    ds_read_b128 v[84:87], v15 offset:37888
    s_cbranch_vccz L_pfF47
    buffer_load_dwordx4 v9, s[12:15], s26 offen offset:1024 sc1 lds
    s_add_u32 s26, s26, s27
L_pfF47:
    s_waitcnt vmcnt(10) lgkmcnt(4)
    v_mfma_f32_32x32x16_bf16 v[32:47], v[64:67], a[192:195], v[32:47]
    ds_read_b128 v[88:91], v15 offset:38912
    buffer_load_dwordx4 a[236:239], v2, s[4:7], s36 offen offset:3072 sc1
    s_add_u32 s36, s36, 4096
    v_mfma_f32_32x32x16_bf16 v[48:63], v[68:71], a[192:195], v[48:63]
    ds_read_b128 v[92:95], v15 offset:39936
    s_waitcnt vmcnt(10) lgkmcnt(4)
    v_mfma_f32_32x32x16_bf16 v[32:47], v[72:75], a[196:199], v[32:47]
    ds_read_b128 v[64:67], v15 offset:40960
    buffer_load_dwordx4 a[240:243], v2, s[4:7], s36 offen offset:0 sc1
    v_mfma_f32_32x32x16_bf16 v[48:63], v[76:79], a[196:199], v[48:63]
    ds_read_b128 v[68:71], v15 offset:41984
    s_cbranch_vccz L_pfF49
    s_add_u32 m0, s28, 40960
    s_nop 0
    buffer_load_dwordx4 v8, s[12:15], s26 offen sc1 lds
L_pfF49:
    s_waitcnt vmcnt(10) lgkmcnt(4)
    v_mfma_f32_32x32x16_bf16 v[32:47], v[80:83], a[200:203], v[32:47]
    ds_read_b128 v[72:75], v15 offset:43008
    buffer_load_dwordx4 a[244:247], v2, s[4:7], s36 offen offset:1024 sc1
    v_mfma_f32_32x32x16_bf16 v[48:63], v[84:87], a[200:203], v[48:63]
    ds_read_b128 v[76:79], v15 offset:44032
    s_waitcnt vmcnt(10) lgkmcnt(4)
    v_mfma_f32_32x32x16_bf16 v[32:47], v[88:91], a[204:207], v[32:47]
    ds_read_b128 v[80:83], v15 offset:45056
    buffer_load_dwordx4 a[248:251], v2, s[4:7], s36 offen offset:2048 sc1
    v_mfma_f32_32x32x16_bf16 v[48:63], v[92:95], a[204:207], v[48:63]
    ds_read_b128 v[84:87], v15 offset:46080
    s_cbranch_vccz L_pfF51
    buffer_load_dwordx4 v9, s[12:15], s26 offen offset:1024 sc1 lds
    s_add_u32 s26, s26, s27
L_pfF51:
    s_waitcnt vmcnt(10) lgkmcnt(4)
    v_mfma_f32_32x32x16_bf16 v[32:47], v[64:67], a[208:211], v[32:47]
    ds_read_b128 v[88:91], v15 offset:47104
    buffer_load_dwordx4 a[252:255], v2, s[4:7], s36 offen offset:3072 sc1
    s_add_u32 s36, s36, 4096
    v_mfma_f32_32x32x16_bf16 v[48:63], v[68:71], a[208:211], v[48:63]
    ds_read_b128 v[92:95], v15 offset:48128
    s_waitcnt vmcnt(10) lgkmcnt(4)
    v_mfma_f32_32x32x16_bf16 v[32:47], v[72:75], a[212:215], v[32:47]
    ds_read_b128 v[64:67], v15 offset:49152
    v_mfma_f32_32x32x16_bf16 v[48:63], v[76:79], a[212:215], v[48:63]
    ds_read_b128 v[68:71], v15 offset:50176
    s_cbranch_vccz L_pfF53
    s_add_u32 m0, s28, 49152
    s_nop 0
    buffer_load_dwordx4 v8, s[12:15], s26 offen sc1 lds
L_pfF53:
    s_waitcnt vmcnt(9) lgkmcnt(4)
    v_mfma_f32_32x32x16_bf16 v[32:47], v[80:83], a[216:219], v[32:47]
    ds_read_b128 v[72:75], v15 offset:51200
    v_mfma_f32_32x32x16_bf16 v[48:63], v[84:87], a[216:219], v[48:63]
    ds_read_b128 v[76:79], v15 offset:52224
    s_waitcnt vmcnt(8) lgkmcnt(4)
    v_mfma_f32_32x32x16_bf16 v[32:47], v[88:91], a[220:223], v[32:47]
    ds_read_b128 v[80:83], v15 offset:53248
    v_mfma_f32_32x32x16_bf16 v[48:63], v[92:95], a[220:223], v[48:63]
    ds_read_b128 v[84:87], v15 offset:54272
    s_cbranch_vccz L_pfF55
    buffer_load_dwordx4 v9, s[12:15], s26 offen offset:1024 sc1 lds
    s_add_u32 s26, s26, s27
L_pfF55:
    s_waitcnt vmcnt(7) lgkmcnt(4)
    v_mfma_f32_32x32x16_bf16 v[32:47], v[64:67], a[224:227], v[32:47]
    ds_read_b128 v[88:91], v15 offset:55296
    v_mfma_f32_32x32x16_bf16 v[48:63], v[68:71], a[224:227], v[48:63]
    ds_read_b128 v[92:95], v15 offset:56320
    s_waitcnt vmcnt(6) lgkmcnt(4)
    v_mfma_f32_32x32x16_bf16 v[32:47], v[72:75], a[228:231], v[32:47]
    ds_read_b128 v[64:67], v15 offset:57344
    v_mfma_f32_32x32x16_bf16 v[48:63], v[76:79], a[228:231], v[48:63]
    ds_read_b128 v[68:71], v15 offset:58368
    s_cbranch_vccz L_pfF57
    s_add_u32 m0, s28, 57344
    s_nop 0
    buffer_load_dwordx4 v8, s[12:15], s26 offen sc1 lds
L_pfF57:
    s_waitcnt vmcnt(5) lgkmcnt(4)
    v_mfma_f32_32x32x16_bf16 v[32:47], v[80:83], a[232:235], v[32:47]
    ds_read_b128 v[72:75], v15 offset:59392
    v_mfma_f32_32x32x16_bf16 v[48:63], v[84:87], a[232:235], v[48:63]
    ds_read_b128 v[76:79], v15 offset:60416
    s_waitcnt vmcnt(4) lgkmcnt(4)
    v_mfma_f32_32x32x16_bf16 v[32:47], v[88:91], a[236:239], v[32:47]
    ds_read_b128 v[80:83], v15 offset:61440
    v_mfma_f32_32x32x16_bf16 v[48:63], v[92:95], a[236:239], v[48:63]
    ds_read_b128 v[84:87], v15 offset:62464
    s_cbranch_vccz L_pfF59
    buffer_load_dwordx4 v9, s[12:15], s26 offen offset:1024 sc1 lds
    s_add_u32 s26, s26, s27
L_pfF59:
    s_waitcnt vmcnt(3) lgkmcnt(4)
    v_mfma_f32_32x32x16_bf16 v[32:47], v[64:67], a[240:243], v[32:47]
    ds_read_b128 v[88:91], v15 offset:63488
    v_mfma_f32_32x32x16_bf16 v[48:63], v[68:71], a[240:243], v[48:63]
    ds_read_b128 v[92:95], v15 offset:64512
    s_waitcnt vmcnt(2) lgkmcnt(4)
    v_mfma_f32_32x32x16_bf16 v[32:47], v[72:75], a[244:247], v[32:47]
    v_mfma_f32_32x32x16_bf16 v[48:63], v[76:79], a[244:247], v[48:63]
    s_waitcnt vmcnt(1) lgkmcnt(2)
    v_mfma_f32_32x32x16_bf16 v[32:47], v[80:83], a[248:251], v[32:47]
    v_mfma_f32_32x32x16_bf16 v[48:63], v[84:87], a[248:251], v[48:63]
    s_waitcnt vmcnt(0) lgkmcnt(0)
    v_mfma_f32_32x32x16_bf16 v[32:47], v[88:91], a[252:255], v[32:47]
    v_mfma_f32_32x32x16_bf16 v[48:63], v[92:95], a[252:255], v[48:63]
    s_nop 7
    s_nop 3
    s_setpc_b64 s[30:31]
L_passB:
    s_barrier
    ds_read_b128 v[64:67], v2 offset:0
    ds_read_b128 v[68:71], v2 offset:1024
    ds_read_b128 v[192:195], v19 offset:0
    ds_read_b128 v[72:75], v2 offset:2048
    ds_read_b128 v[76:79], v2 offset:3072
    ds_read_b128 v[196:199], v19 offset:272
    ds_read_b128 v[80:83], v2 offset:4096
    ds_read_b128 v[84:87], v2 offset:5120
    ds_read_b128 v[200:203], v19 offset:544
    s_waitcnt vmcnt(7) lgkmcnt(6)
    v_mfma_f32_32x32x16_bf16 v[32:47], v[64:67], a[0:3], 0
    ds_read_b128 v[88:91], v2 offset:6144
    buffer_load_dwordx4 a[32:35], v2, s[4:7], s36 offen offset:0 sc1
    v_mfma_f32_32x32x16_bf16 v[48:63], v[68:71], a[0:3], 0
    ds_read_b128 v[92:95], v2 offset:7168
    ds_read_b128 v[204:207], v19 offset:816
    buffer_load_dwordx4 a[36:39], v2, s[4:7], s36 offen offset:1024 sc1
    v_mfma_f32_16x16x32_bf16 v[188:191], v[192:195], a[0:3], 0
    s_waitcnt vmcnt(8) lgkmcnt(6)
    v_mfma_f32_32x32x16_bf16 v[32:47], v[72:75], a[4:7], v[32:47]
    ds_read_b128 v[64:67], v2 offset:8192
    buffer_load_dwordx4 a[40:43], v2, s[4:7], s36 offen offset:2048 sc1
    v_mfma_f32_32x32x16_bf16 v[48:63], v[76:79], a[4:7], v[48:63]
    ds_read_b128 v[68:71], v2 offset:9216
    ds_read_b128 v[192:195], v19 offset:1088
    buffer_load_dwordx4 a[44:47], v2, s[4:7], s36 offen offset:3072 sc1
    s_add_u32 s36, s36, 4096
    v_mfma_f32_16x16x32_bf16 v[188:191], v[196:199], a[4:7], v[188:191]
    s_waitcnt vmcnt(9) lgkmcnt(6)
    v_mfma_f32_32x32x16_bf16 v[32:47], v[80:83], a[8:11], v[32:47]
    ds_read_b128 v[72:75], v2 offset:10240
    buffer_load_dwordx4 a[48:51], v2, s[4:7], s36 offen offset:0 sc1
    v_mfma_f32_32x32x16_bf16 v[48:63], v[84:87], a[8:11], v[48:63]
    ds_read_b128 v[76:79], v2 offset:11264
    ds_read_b128 v[196:199], v19 offset:1360
    buffer_load_dwordx4 a[52:55], v2, s[4:7], s36 offen offset:1024 sc1
    v_mfma_f32_16x16x32_bf16 v[188:191], v[200:203], a[8:11], v[188:191]
    s_waitcnt vmcnt(10) lgkmcnt(6)
    v_mfma_f32_32x32x16_bf16 v[32:47], v[88:91], a[12:15], v[32:47]
    ds_read_b128 v[80:83], v2 offset:12288
    buffer_load_dwordx4 a[56:59], v2, s[4:7], s36 offen offset:2048 sc1
    v_mfma_f32_32x32x16_bf16 v[48:63], v[92:95], a[12:15], v[48:63]
    ds_read_b128 v[84:87], v2 offset:13312
    ds_read_b128 v[200:203], v19 offset:1632
    v_mfma_f32_16x16x32_bf16 v[188:191], v[204:207], a[12:15], v[188:191]
    s_waitcnt vmcnt(10) lgkmcnt(6)
    v_mfma_f32_32x32x16_bf16 v[32:47], v[64:67], a[16:19], v[32:47]
    ds_read_b128 v[88:91], v2 offset:14336
    buffer_load_dwordx4 a[60:63], v2, s[4:7], s36 offen offset:3072 sc1
    s_add_u32 s36, s36, 4096
    v_mfma_f32_32x32x16_bf16 v[48:63], v[68:71], a[16:19], v[48:63]
    ds_read_b128 v[92:95], v2 offset:15360
    ds_read_b128 v[204:207], v19 offset:1904
    v_mfma_f32_16x16x32_bf16 v[188:191], v[192:195], a[16:19], v[188:191]
    s_waitcnt vmcnt(10) lgkmcnt(6)
    v_mfma_f32_32x32x16_bf16 v[32:47], v[72:75], a[20:23], v[32:47]
    ds_read_b128 v[64:67], v2 offset:16384
    buffer_load_dwordx4 a[64:67], v2, s[4:7], s36 offen offset:0 sc1
    v_mfma_f32_32x32x16_bf16 v[48:63], v[76:79], a[20:23], v[48:63]
    ds_read_b128 v[68:71], v2 offset:17408
    ds_read_b128 v[192:195], v19 offset:2176
    v_mfma_f32_16x16x32_bf16 v[188:191], v[196:199], a[20:23], v[188:191]
    s_waitcnt vmcnt(10) lgkmcnt(6)
    v_mfma_f32_32x32x16_bf16 v[32:47], v[80:83], a[24:27], v[32:47]
    ds_read_b128 v[72:75], v2 offset:18432
    buffer_load_dwordx4 a[68:71], v2, s[4:7], s36 offen offset:1024 sc1
    v_mfma_f32_32x32x16_bf16 v[48:63], v[84:87], a[24:27], v[48:63]
    ds_read_b128 v[76:79], v2 offset:19456
    ds_read_b128 v[196:199], v19 offset:2448
    v_mfma_f32_16x16x32_bf16 v[188:191], v[200:203], a[24:27], v[188:191]
    s_waitcnt vmcnt(10) lgkmcnt(6)
    v_mfma_f32_32x32x16_bf16 v[32:47], v[88:91], a[28:31], v[32:47]
    ds_read_b128 v[80:83], v2 offset:20480
    buffer_load_dwordx4 a[72:75], v2, s[4:7], s36 offen offset:2048 sc1
    v_mfma_f32_32x32x16_bf16 v[48:63], v[92:95], a[28:31], v[48:63]
    ds_read_b128 v[84:87], v2 offset:21504
    ds_read_b128 v[200:203], v19 offset:2720
    v_mfma_f32_16x16x32_bf16 v[188:191], v[204:207], a[28:31], v[188:191]
    s_waitcnt vmcnt(10) lgkmcnt(6)
    v_mfma_f32_32x32x16_bf16 v[32:47], v[64:67], a[32:35], v[32:47]
    ds_read_b128 v[88:91], v2 offset:22528
    buffer_load_dwordx4 a[76:79], v2, s[4:7], s36 offen offset:3072 sc1
    s_add_u32 s36, s36, 4096
    v_mfma_f32_32x32x16_bf16 v[48:63], v[68:71], a[32:35], v[48:63]
    ds_read_b128 v[92:95], v2 offset:23552
    ds_read_b128 v[204:207], v19 offset:2992
    v_mfma_f32_16x16x32_bf16 v[188:191], v[192:195], a[32:35], v[188:191]
    s_waitcnt vmcnt(10) lgkmcnt(6)
    v_mfma_f32_32x32x16_bf16 v[32:47], v[72:75], a[36:39], v[32:47]
    ds_read_b128 v[64:67], v2 offset:24576
    buffer_load_dwordx4 a[80:83], v2, s[4:7], s36 offen offset:0 sc1
    v_mfma_f32_32x32x16_bf16 v[48:63], v[76:79], a[36:39], v[48:63]
    ds_read_b128 v[68:71], v2 offset:25600
    ds_read_b128 v[192:195], v19 offset:3264
    v_mfma_f32_16x16x32_bf16 v[188:191], v[196:199], a[36:39], v[188:191]
    s_waitcnt vmcnt(10) lgkmcnt(6)
    v_mfma_f32_32x32x16_bf16 v[32:47], v[80:83], a[40:43], v[32:47]
    ds_read_b128 v[72:75], v2 offset:26624
    buffer_load_dwordx4 a[84:87], v2, s[4:7], s36 offen offset:1024 sc1
    v_mfma_f32_32x32x16_bf16 v[48:63], v[84:87], a[40:43], v[48:63]
    ds_read_b128 v[76:79], v2 offset:27648
    ds_read_b128 v[196:199], v19 offset:3536
    v_mfma_f32_16x16x32_bf16 v[188:191], v[200:203], a[40:43], v[188:191]
    s_waitcnt vmcnt(10) lgkmcnt(6)
    v_mfma_f32_32x32x16_bf16 v[32:47], v[88:91], a[44:47], v[32:47]
    ds_read_b128 v[80:83], v2 offset:28672
    buffer_load_dwordx4 a[88:91], v2, s[4:7], s36 offen offset:2048 sc1
    v_mfma_f32_32x32x16_bf16 v[48:63], v[92:95], a[44:47], v[48:63]
    ds_read_b128 v[84:87], v2 offset:29696
    ds_read_b128 v[200:203], v19 offset:3808
    v_mfma_f32_16x16x32_bf16 v[188:191], v[204:207], a[44:47], v[188:191]
    s_waitcnt vmcnt(10) lgkmcnt(6)
    v_mfma_f32_32x32x16_bf16 v[32:47], v[64:67], a[48:51], v[32:47]
    ds_read_b128 v[88:91], v2 offset:30720
    buffer_load_dwordx4 a[92:95], v2, s[4:7], s36 offen offset:3072 sc1
    s_add_u32 s36, s36, 4096
    v_mfma_f32_32x32x16_bf16 v[48:63], v[68:71], a[48:51], v[48:63]
    ds_read_b128 v[92:95], v2 offset:31744
    ds_read_b128 v[204:207], v19 offset:4080
    v_mfma_f32_16x16x32_bf16 v[188:191], v[192:195], a[48:51], v[188:191]
    s_waitcnt vmcnt(10) lgkmcnt(6)
    v_mfma_f32_32x32x16_bf16 v[32:47], v[72:75], a[52:55], v[32:47]
    ds_read_b128 v[64:67], v2 offset:32768
    buffer_load_dwordx4 a[96:99], v2, s[4:7], s36 offen offset:0 sc1
    v_mfma_f32_32x32x16_bf16 v[48:63], v[76:79], a[52:55], v[48:63]
    ds_read_b128 v[68:71], v2 offset:33792
    ds_read_b128 v[192:195], v19 offset:4352
    v_mfma_f32_16x16x32_bf16 v[188:191], v[196:199], a[52:55], v[188:191]
    s_waitcnt vmcnt(10) lgkmcnt(6)
    v_mfma_f32_32x32x16_bf16 v[32:47], v[80:83], a[56:59], v[32:47]
    ds_read_b128 v[72:75], v2 offset:34816
    buffer_load_dwordx4 a[100:103], v2, s[4:7], s36 offen offset:1024 sc1
    v_mfma_f32_32x32x16_bf16 v[48:63], v[84:87], a[56:59], v[48:63]
    ds_read_b128 v[76:79], v2 offset:35840
    ds_read_b128 v[196:199], v19 offset:4624
    v_mfma_f32_16x16x32_bf16 v[188:191], v[200:203], a[56:59], v[188:191]
    s_waitcnt vmcnt(10) lgkmcnt(6)
    v_mfma_f32_32x32x16_bf16 v[32:47], v[88:91], a[60:63], v[32:47]
    ds_read_b128 v[80:83], v2 offset:36864
    buffer_load_dwordx4 a[104:107], v2, s[4:7], s36 offen offset:2048 sc1
    v_mfma_f32_32x32x16_bf16 v[48:63], v[92:95], a[60:63], v[48:63]
    ds_read_b128 v[84:87], v2 offset:37888
    ds_read_b128 v[200:203], v19 offset:4896
    v_mfma_f32_16x16x32_bf16 v[188:191], v[204:207], a[60:63], v[188:191]
    s_waitcnt vmcnt(10) lgkmcnt(6)
    v_mfma_f32_32x32x16_bf16 v[32:47], v[64:67], a[64:67], v[32:47]
    ds_read_b128 v[88:91], v2 offset:38912
    buffer_load_dwordx4 a[108:111], v2, s[4:7], s36 offen offset:3072 sc1
    s_add_u32 s36, s36, 4096
    v_mfma_f32_32x32x16_bf16 v[48:63], v[68:71], a[64:67], v[48:63]
    ds_read_b128 v[92:95], v2 offset:39936
    ds_read_b128 v[204:207], v19 offset:5168
    v_mfma_f32_16x16x32_bf16 v[188:191], v[192:195], a[64:67], v[188:191]
    s_waitcnt vmcnt(10) lgkmcnt(6)
    v_mfma_f32_32x32x16_bf16 v[32:47], v[72:75], a[68:71], v[32:47]
    ds_read_b128 v[64:67], v2 offset:40960
    buffer_load_dwordx4 a[112:115], v2, s[4:7], s36 offen offset:0 sc1
    v_mfma_f32_32x32x16_bf16 v[48:63], v[76:79], a[68:71], v[48:63]
    ds_read_b128 v[68:71], v2 offset:41984
    ds_read_b128 v[192:195], v19 offset:5440
    v_mfma_f32_16x16x32_bf16 v[188:191], v[196:199], a[68:71], v[188:191]
    s_waitcnt vmcnt(10) lgkmcnt(6)
    v_mfma_f32_32x32x16_bf16 v[32:47], v[80:83], a[72:75], v[32:47]
    ds_read_b128 v[72:75], v2 offset:43008
    buffer_load_dwordx4 a[116:119], v2, s[4:7], s36 offen offset:1024 sc1
    v_mfma_f32_32x32x16_bf16 v[48:63], v[84:87], a[72:75], v[48:63]
    ds_read_b128 v[76:79], v2 offset:44032
    ds_read_b128 v[196:199], v19 offset:5712
    v_mfma_f32_16x16x32_bf16 v[188:191], v[200:203], a[72:75], v[188:191]
    s_waitcnt vmcnt(10) lgkmcnt(6)
    v_mfma_f32_32x32x16_bf16 v[32:47], v[88:91], a[76:79], v[32:47]
    ds_read_b128 v[80:83], v2 offset:45056
    buffer_load_dwordx4 a[120:123], v2, s[4:7], s36 offen offset:2048 sc1
    v_mfma_f32_32x32x16_bf16 v[48:63], v[92:95], a[76:79], v[48:63]
    ds_read_b128 v[84:87], v2 offset:46080
    ds_read_b128 v[200:203], v19 offset:5984
    v_mfma_f32_16x16x32_bf16 v[188:191], v[204:207], a[76:79], v[188:191]
    s_waitcnt vmcnt(10) lgkmcnt(6)
    v_mfma_f32_32x32x16_bf16 v[32:47], v[64:67], a[80:83], v[32:47]
    ds_read_b128 v[88:91], v2 offset:47104
    buffer_load_dwordx4 a[124:127], v2, s[4:7], s36 offen offset:3072 sc1
    s_add_u32 s36, s36, 4096
    v_mfma_f32_32x32x16_bf16 v[48:63], v[68:71], a[80:83], v[48:63]
    ds_read_b128 v[92:95], v2 offset:48128
    ds_read_b128 v[204:207], v19 offset:6256
    v_mfma_f32_16x16x32_bf16 v[188:191], v[192:195], a[80:83], v[188:191]
    s_waitcnt vmcnt(10) lgkmcnt(6)
    v_mfma_f32_32x32x16_bf16 v[32:47], v[72:75], a[84:87], v[32:47]
    ds_read_b128 v[64:67], v2 offset:49152
    buffer_load_dwordx4 a[128:131], v2, s[4:7], s36 offen offset:0 sc1
    v_mfma_f32_32x32x16_bf16 v[48:63], v[76:79], a[84:87], v[48:63]
    ds_read_b128 v[68:71], v2 offset:50176
    ds_read_b128 v[192:195], v19 offset:6528
    v_mfma_f32_16x16x32_bf16 v[188:191], v[196:199], a[84:87], v[188:191]
    s_waitcnt vmcnt(10) lgkmcnt(6)
    v_mfma_f32_32x32x16_bf16 v[32:47], v[80:83], a[88:91], v[32:47]
    ds_read_b128 v[72:75], v2 offset:51200
    buffer_load_dwordx4 a[132:135], v2, s[4:7], s36 offen offset:1024 sc1
    v_mfma_f32_32x32x16_bf16 v[48:63], v[84:87], a[88:91], v[48:63]
    ds_read_b128 v[76:79], v2 offset:52224
    ds_read_b128 v[196:199], v19 offset:6800
    v_mfma_f32_16x16x32_bf16 v[188:191], v[200:203], a[88:91], v[188:191]
    s_waitcnt vmcnt(10) lgkmcnt(6)
    v_mfma_f32_32x32x16_bf16 v[32:47], v[88:91], a[92:95], v[32:47]
    ds_read_b128 v[80:83], v2 offset:53248
    buffer_load_dwordx4 a[136:139], v2, s[4:7], s36 offen offset:2048 sc1
    v_mfma_f32_32x32x16_bf16 v[48:63], v[92:95], a[92:95], v[48:63]
    ds_read_b128 v[84:87], v2 offset:54272
    ds_read_b128 v[200:203], v19 offset:7072
    v_mfma_f32_16x16x32_bf16 v[188:191], v[204:207], a[92:95], v[188:191]
    s_waitcnt vmcnt(10) lgkmcnt(6)
    v_mfma_f32_32x32x16_bf16 v[32:47], v[64:67], a[96:99], v[32:47]
    ds_read_b128 v[88:91], v2 offset:55296
    buffer_load_dwordx4 a[140:143], v2, s[4:7], s36 offen offset:3072 sc1
    s_add_u32 s36, s36, 4096
    v_mfma_f32_32x32x16_bf16 v[48:63], v[68:71], a[96:99], v[48:63]
    ds_read_b128 v[92:95], v2 offset:56320
    ds_read_b128 v[204:207], v19 offset:7344
    v_mfma_f32_16x16x32_bf16 v[188:191], v[192:195], a[96:99], v[188:191]
    s_waitcnt vmcnt(10) lgkmcnt(6)
    v_mfma_f32_32x32x16_bf16 v[32:47], v[72:75], a[100:103], v[32:47]
    ds_read_b128 v[64:67], v2 offset:57344
    buffer_load_dwordx4 a[144:147], v2, s[4:7], s36 offen offset:0 sc1
    v_mfma_f32_32x32x16_bf16 v[48:63], v[76:79], a[100:103], v[48:63]
    ds_read_b128 v[68:71], v2 offset:58368
    ds_read_b128 v[192:195], v19 offset:7616
    v_mfma_f32_16x16x32_bf16 v[188:191], v[196:199], a[100:103], v[188:191]
    s_waitcnt vmcnt(10) lgkmcnt(6)
    v_mfma_f32_32x32x16_bf16 v[32:47], v[80:83], a[104:107], v[32:47]
    ds_read_b128 v[72:75], v2 offset:59392
    buffer_load_dwordx4 a[148:151], v2, s[4:7], s36 offen offset:1024 sc1
    v_mfma_f32_32x32x16_bf16 v[48:63], v[84:87], a[104:107], v[48:63]
    ds_read_b128 v[76:79], v2 offset:60416
    ds_read_b128 v[196:199], v19 offset:7888
    v_mfma_f32_16x16x32_bf16 v[188:191], v[200:203], a[104:107], v[188:191]
    s_waitcnt vmcnt(10) lgkmcnt(6)
    v_mfma_f32_32x32x16_bf16 v[32:47], v[88:91], a[108:111], v[32:47]
    ds_read_b128 v[80:83], v2 offset:61440
    buffer_load_dwordx4 a[152:155], v2, s[4:7], s36 offen offset:2048 sc1
    v_mfma_f32_32x32x16_bf16 v[48:63], v[92:95], a[108:111], v[48:63]
    ds_read_b128 v[84:87], v2 offset:62464
    ds_read_b128 v[200:203], v19 offset:8160
    v_mfma_f32_16x16x32_bf16 v[188:191], v[204:207], a[108:111], v[188:191]
    s_waitcnt vmcnt(10) lgkmcnt(6)
    v_mfma_f32_32x32x16_bf16 v[32:47], v[64:67], a[112:115], v[32:47]
    ds_read_b128 v[88:91], v2 offset:63488
    buffer_load_dwordx4 a[156:159], v2, s[4:7], s36 offen offset:3072 sc1
    s_add_u32 s36, s36, 4096
    v_mfma_f32_32x32x16_bf16 v[48:63], v[68:71], a[112:115], v[48:63]
    ds_read_b128 v[92:95], v2 offset:64512
    ds_read_b128 v[204:207], v19 offset:8432
    v_mfma_f32_16x16x32_bf16 v[188:191], v[192:195], a[112:115], v[188:191]
    s_waitcnt vmcnt(10) lgkmcnt(6)
    v_mfma_f32_32x32x16_bf16 v[32:47], v[72:75], a[116:119], v[32:47]
    ds_read_b128 v[64:67], v15 offset:0
    buffer_load_dwordx4 a[160:163], v2, s[4:7], s36 offen offset:0 sc1
    v_mfma_f32_32x32x16_bf16 v[48:63], v[76:79], a[116:119], v[48:63]
    ds_read_b128 v[68:71], v15 offset:1024
    ds_read_b128 v[192:195], v19 offset:8704
    v_mfma_f32_16x16x32_bf16 v[188:191], v[196:199], a[116:119], v[188:191]
    s_waitcnt vmcnt(10) lgkmcnt(6)
    v_mfma_f32_32x32x16_bf16 v[32:47], v[80:83], a[120:123], v[32:47]
    ds_read_b128 v[72:75], v15 offset:2048
    buffer_load_dwordx4 a[164:167], v2, s[4:7], s36 offen offset:1024 sc1
    v_mfma_f32_32x32x16_bf16 v[48:63], v[84:87], a[120:123], v[48:63]
    ds_read_b128 v[76:79], v15 offset:3072
    ds_read_b128 v[196:199], v19 offset:8976
    v_mfma_f32_16x16x32_bf16 v[188:191], v[200:203], a[120:123], v[188:191]
    s_waitcnt vmcnt(10) lgkmcnt(6)
    v_mfma_f32_32x32x16_bf16 v[32:47], v[88:91], a[124:127], v[32:47]
    ds_read_b128 v[80:83], v15 offset:4096
    buffer_load_dwordx4 a[168:171], v2, s[4:7], s36 offen offset:2048 sc1
    v_mfma_f32_32x32x16_bf16 v[48:63], v[92:95], a[124:127], v[48:63]
    ds_read_b128 v[84:87], v15 offset:5120
    ds_read_b128 v[200:203], v19 offset:9248
    v_mfma_f32_16x16x32_bf16 v[188:191], v[204:207], a[124:127], v[188:191]
    s_waitcnt vmcnt(10) lgkmcnt(6)
    v_mfma_f32_32x32x16_bf16 v[32:47], v[64:67], a[128:131], v[32:47]
    ds_read_b128 v[88:91], v15 offset:6144
    buffer_load_dwordx4 a[172:175], v2, s[4:7], s36 offen offset:3072 sc1
    s_add_u32 s36, s36, 4096
    v_mfma_f32_32x32x16_bf16 v[48:63], v[68:71], a[128:131], v[48:63]
    ds_read_b128 v[92:95], v15 offset:7168
    ds_read_b128 v[204:207], v19 offset:9520
    v_mfma_f32_16x16x32_bf16 v[188:191], v[192:195], a[128:131], v[188:191]
    s_waitcnt vmcnt(10) lgkmcnt(6)
    v_mfma_f32_32x32x16_bf16 v[32:47], v[72:75], a[132:135], v[32:47]
    ds_read_b128 v[64:67], v15 offset:8192
    buffer_load_dwordx4 a[176:179], v2, s[4:7], s36 offen offset:0 sc1
    v_mfma_f32_32x32x16_bf16 v[48:63], v[76:79], a[132:135], v[48:63]
    ds_read_b128 v[68:71], v15 offset:9216
    ds_read_b128 v[192:195], v19 offset:9792
    v_mfma_f32_16x16x32_bf16 v[188:191], v[196:199], a[132:135], v[188:191]
    s_waitcnt vmcnt(10) lgkmcnt(6)
    v_mfma_f32_32x32x16_bf16 v[32:47], v[80:83], a[136:139], v[32:47]
    ds_read_b128 v[72:75], v15 offset:10240
    buffer_load_dwordx4 a[180:183], v2, s[4:7], s36 offen offset:1024 sc1
    v_mfma_f32_32x32x16_bf16 v[48:63], v[84:87], a[136:139], v[48:63]
    ds_read_b128 v[76:79], v15 offset:11264
    ds_read_b128 v[196:199], v19 offset:10064
    v_mfma_f32_16x16x32_bf16 v[188:191], v[200:203], a[136:139], v[188:191]
    s_waitcnt vmcnt(10) lgkmcnt(6)
    v_mfma_f32_32x32x16_bf16 v[32:47], v[88:91], a[140:143], v[32:47]
    ds_read_b128 v[80:83], v15 offset:12288
    buffer_load_dwordx4 a[184:187], v2, s[4:7], s36 offen offset:2048 sc1
    v_mfma_f32_32x32x16_bf16 v[48:63], v[92:95], a[140:143], v[48:63]
    ds_read_b128 v[84:87], v15 offset:13312
    ds_read_b128 v[200:203], v19 offset:10336
    v_mfma_f32_16x16x32_bf16 v[188:191], v[204:207], a[140:143], v[188:191]
    s_waitcnt vmcnt(10) lgkmcnt(6)
    v_mfma_f32_32x32x16_bf16 v[32:47], v[64:67], a[144:147], v[32:47]
    ds_read_b128 v[88:91], v15 offset:14336
    buffer_load_dwordx4 a[188:191], v2, s[4:7], s36 offen offset:3072 sc1
    s_add_u32 s36, s36, 4096
    v_mfma_f32_32x32x16_bf16 v[48:63], v[68:71], a[144:147], v[48:63]
    ds_read_b128 v[92:95], v15 offset:15360
    ds_read_b128 v[204:207], v19 offset:10608
    v_mfma_f32_16x16x32_bf16 v[188:191], v[192:195], a[144:147], v[188:191]
    s_waitcnt vmcnt(10) lgkmcnt(6)
    v_mfma_f32_32x32x16_bf16 v[32:47], v[72:75], a[148:151], v[32:47]
    ds_read_b128 v[64:67], v15 offset:16384
    buffer_load_dwordx4 a[192:195], v2, s[4:7], s36 offen offset:0 sc1
    v_mfma_f32_32x32x16_bf16 v[48:63], v[76:79], a[148:151], v[48:63]
    ds_read_b128 v[68:71], v15 offset:17408
    ds_read_b128 v[192:195], v19 offset:10880
    v_mfma_f32_16x16x32_bf16 v[188:191], v[196:199], a[148:151], v[188:191]
    s_waitcnt vmcnt(10) lgkmcnt(6)
    v_mfma_f32_32x32x16_bf16 v[32:47], v[80:83], a[152:155], v[32:47]
    ds_read_b128 v[72:75], v15 offset:18432
    buffer_load_dwordx4 a[196:199], v2, s[4:7], s36 offen offset:1024 sc1
    v_mfma_f32_32x32x16_bf16 v[48:63], v[84:87], a[152:155], v[48:63]
    ds_read_b128 v[76:79], v15 offset:19456
    ds_read_b128 v[196:199], v19 offset:11152
    v_mfma_f32_16x16x32_bf16 v[188:191], v[200:203], a[152:155], v[188:191]
    s_waitcnt vmcnt(10) lgkmcnt(6)
    v_mfma_f32_32x32x16_bf16 v[32:47], v[88:91], a[156:159], v[32:47]
    ds_read_b128 v[80:83], v15 offset:20480
    buffer_load_dwordx4 a[200:203], v2, s[4:7], s36 offen offset:2048 sc1
    v_mfma_f32_32x32x16_bf16 v[48:63], v[92:95], a[156:159], v[48:63]
    ds_read_b128 v[84:87], v15 offset:21504
    ds_read_b128 v[200:203], v19 offset:11424
    v_mfma_f32_16x16x32_bf16 v[188:191], v[204:207], a[156:159], v[188:191]
    s_waitcnt vmcnt(10) lgkmcnt(6)
    v_mfma_f32_32x32x16_bf16 v[32:47], v[64:67], a[160:163], v[32:47]
    ds_read_b128 v[88:91], v15 offset:22528
    buffer_load_dwordx4 a[204:207], v2, s[4:7], s36 offen offset:3072 sc1
    s_add_u32 s36, s36, 4096
    v_mfma_f32_32x32x16_bf16 v[48:63], v[68:71], a[160:163], v[48:63]
    ds_read_b128 v[92:95], v15 offset:23552
    ds_read_b128 v[204:207], v19 offset:11696
    v_mfma_f32_16x16x32_bf16 v[188:191], v[192:195], a[160:163], v[188:191]
    s_waitcnt vmcnt(10) lgkmcnt(6)
    v_mfma_f32_32x32x16_bf16 v[32:47], v[72:75], a[164:167], v[32:47]
    ds_read_b128 v[64:67], v15 offset:24576
    buffer_load_dwordx4 a[208:211], v2, s[4:7], s36 offen offset:0 sc1
    v_mfma_f32_32x32x16_bf16 v[48:63], v[76:79], a[164:167], v[48:63]
    ds_read_b128 v[68:71], v15 offset:25600
    ds_read_b128 v[192:195], v19 offset:11968
    v_mfma_f32_16x16x32_bf16 v[188:191], v[196:199], a[164:167], v[188:191]
    s_waitcnt vmcnt(10) lgkmcnt(6)
    v_mfma_f32_32x32x16_bf16 v[32:47], v[80:83], a[168:171], v[32:47]
    ds_read_b128 v[72:75], v15 offset:26624
    buffer_load_dwordx4 a[212:215], v2, s[4:7], s36 offen offset:1024 sc1
    v_mfma_f32_32x32x16_bf16 v[48:63], v[84:87], a[168:171], v[48:63]
    ds_read_b128 v[76:79], v15 offset:27648
    ds_read_b128 v[196:199], v19 offset:12240
    v_mfma_f32_16x16x32_bf16 v[188:191], v[200:203], a[168:171], v[188:191]
    s_waitcnt vmcnt(10) lgkmcnt(6)
    v_mfma_f32_32x32x16_bf16 v[32:47], v[88:91], a[172:175], v[32:47]
    ds_read_b128 v[80:83], v15 offset:28672
    buffer_load_dwordx4 a[216:219], v2, s[4:7], s36 offen offset:2048 sc1
    v_mfma_f32_32x32x16_bf16 v[48:63], v[92:95], a[172:175], v[48:63]
    ds_read_b128 v[84:87], v15 offset:29696
    ds_read_b128 v[200:203], v19 offset:12512
    v_mfma_f32_16x16x32_bf16 v[188:191], v[204:207], a[172:175], v[188:191]
    s_waitcnt vmcnt(10) lgkmcnt(6)
    v_mfma_f32_32x32x16_bf16 v[32:47], v[64:67], a[176:179], v[32:47]
    ds_read_b128 v[88:91], v15 offset:30720
    buffer_load_dwordx4 a[220:223], v2, s[4:7], s36 offen offset:3072 sc1
    s_add_u32 s36, s36, 4096
    v_mfma_f32_32x32x16_bf16 v[48:63], v[68:71], a[176:179], v[48:63]
    ds_read_b128 v[92:95], v15 offset:31744
    ds_read_b128 v[204:207], v19 offset:12784
    v_mfma_f32_16x16x32_bf16 v[188:191], v[192:195], a[176:179], v[188:191]
    s_waitcnt vmcnt(10) lgkmcnt(6)
    v_mfma_f32_32x32x16_bf16 v[32:47], v[72:75], a[180:183], v[32:47]
    ds_read_b128 v[64:67], v15 offset:32768
    buffer_load_dwordx4 a[224:227], v2, s[4:7], s36 offen offset:0 sc1
    v_mfma_f32_32x32x16_bf16 v[48:63], v[76:79], a[180:183], v[48:63]
    ds_read_b128 v[68:71], v15 offset:33792
    ds_read_b128 v[192:195], v19 offset:13056
    v_mfma_f32_16x16x32_bf16 v[188:191], v[196:199], a[180:183], v[188:191]
    s_waitcnt vmcnt(10) lgkmcnt(6)
    v_mfma_f32_32x32x16_bf16 v[32:47], v[80:83], a[184:187], v[32:47]
    ds_read_b128 v[72:75], v15 offset:34816
    buffer_load_dwordx4 a[228:231], v2, s[4:7], s36 offen offset:1024 sc1
    v_mfma_f32_32x32x16_bf16 v[48:63], v[84:87], a[184:187], v[48:63]
    ds_read_b128 v[76:79], v15 offset:35840
    ds_read_b128 v[196:199], v19 offset:13328
    v_mfma_f32_16x16x32_bf16 v[188:191], v[200:203], a[184:187], v[188:191]
    s_waitcnt vmcnt(10) lgkmcnt(6)
    v_mfma_f32_32x32x16_bf16 v[32:47], v[88:91], a[188:191], v[32:47]
    ds_read_b128 v[80:83], v15 offset:36864
    buffer_load_dwordx4 a[232:235], v2, s[4:7], s36 offen offset:2048 sc1
    v_mfma_f32_32x32x16_bf16 v[48:63], v[92:95], a[188:191], v[48:63]
    ds_read_b128 v[84:87], v15 offset:37888
    ds_read_b128 v[200:203], v19 offset:13600
    v_mfma_f32_16x16x32_bf16 v[188:191], v[204:207], a[188:191], v[188:191]
    s_waitcnt vmcnt(10) lgkmcnt(6)
    v_mfma_f32_32x32x16_bf16 v[32:47], v[64:67], a[192:195], v[32:47]
    ds_read_b128 v[88:91], v15 offset:38912
    buffer_load_dwordx4 a[236:239], v2, s[4:7], s36 offen offset:3072 sc1
    s_add_u32 s36, s36, 4096
    v_mfma_f32_32x32x16_bf16 v[48:63], v[68:71], a[192:195], v[48:63]
    ds_read_b128 v[92:95], v15 offset:39936
    ds_read_b128 v[204:207], v19 offset:13872
    v_mfma_f32_16x16x32_bf16 v[188:191], v[192:195], a[192:195], v[188:191]
    s_waitcnt vmcnt(10) lgkmcnt(6)
    v_mfma_f32_32x32x16_bf16 v[32:47], v[72:75], a[196:199], v[32:47]
    ds_read_b128 v[64:67], v15 offset:40960
    buffer_load_dwordx4 a[240:243], v2, s[4:7], s36 offen offset:0 sc1
    v_mfma_f32_32x32x16_bf16 v[48:63], v[76:79], a[196:199], v[48:63]
    ds_read_b128 v[68:71], v15 offset:41984
    ds_read_b128 v[192:195], v19 offset:14144
    v_mfma_f32_16x16x32_bf16 v[188:191], v[196:199], a[196:199], v[188:191]
    s_waitcnt vmcnt(10) lgkmcnt(6)
    v_mfma_f32_32x32x16_bf16 v[32:47], v[80:83], a[200:203], v[32:47]
    ds_read_b128 v[72:75], v15 offset:43008
    buffer_load_dwordx4 a[244:247], v2, s[4:7], s36 offen offset:1024 sc1
    v_mfma_f32_32x32x16_bf16 v[48:63], v[84:87], a[200:203], v[48:63]
    ds_read_b128 v[76:79], v15 offset:44032
    ds_read_b128 v[196:199], v19 offset:14416
    v_mfma_f32_16x16x32_bf16 v[188:191], v[200:203], a[200:203], v[188:191]
    s_waitcnt vmcnt(10) lgkmcnt(6)
    v_mfma_f32_32x32x16_bf16 v[32:47], v[88:91], a[204:207], v[32:47]
    ds_read_b128 v[80:83], v15 offset:45056
    buffer_load_dwordx4 a[248:251], v2, s[4:7], s36 offen offset:2048 sc1
    v_mfma_f32_32x32x16_bf16 v[48:63], v[92:95], a[204:207], v[48:63]
    ds_read_b128 v[84:87], v15 offset:46080
    ds_read_b128 v[200:203], v19 offset:14688
    v_mfma_f32_16x16x32_bf16 v[188:191], v[204:207], a[204:207], v[188:191]
    s_waitcnt vmcnt(10) lgkmcnt(6)
    v_mfma_f32_32x32x16_bf16 v[32:47], v[64:67], a[208:211], v[32:47]
    ds_read_b128 v[88:91], v15 offset:47104
    buffer_load_dwordx4 a[252:255], v2, s[4:7], s36 offen offset:3072 sc1
    s_add_u32 s36, s36, 4096
    v_mfma_f32_32x32x16_bf16 v[48:63], v[68:71], a[208:211], v[48:63]
    ds_read_b128 v[92:95], v15 offset:48128
    ds_read_b128 v[204:207], v19 offset:14960
    v_mfma_f32_16x16x32_bf16 v[188:191], v[192:195], a[208:211], v[188:191]
    s_waitcnt vmcnt(10) lgkmcnt(6)
    v_mfma_f32_32x32x16_bf16 v[32:47], v[72:75], a[212:215], v[32:47]
    ds_read_b128 v[64:67], v15 offset:49152
    v_mfma_f32_32x32x16_bf16 v[48:63], v[76:79], a[212:215], v[48:63]
    ds_read_b128 v[68:71], v15 offset:50176
    ds_read_b128 v[192:195], v19 offset:15232
    v_mfma_f32_16x16x32_bf16 v[188:191], v[196:199], a[212:215], v[188:191]
    s_waitcnt vmcnt(9) lgkmcnt(6)
    v_mfma_f32_32x32x16_bf16 v[32:47], v[80:83], a[216:219], v[32:47]
    ds_read_b128 v[72:75], v15 offset:51200
    v_mfma_f32_32x32x16_bf16 v[48:63], v[84:87], a[216:219], v[48:63]
    ds_read_b128 v[76:79], v15 offset:52224
    ds_read_b128 v[196:199], v19 offset:15504
    v_mfma_f32_16x16x32_bf16 v[188:191], v[200:203], a[216:219], v[188:191]
    s_waitcnt vmcnt(8) lgkmcnt(6)
    v_mfma_f32_32x32x16_bf16 v[32:47], v[88:91], a[220:223], v[32:47]
    ds_read_b128 v[80:83], v15 offset:53248
    v_mfma_f32_32x32x16_bf16 v[48:63], v[92:95], a[220:223], v[48:63]
    ds_read_b128 v[84:87], v15 offset:54272
    ds_read_b128 v[200:203], v19 offset:15776
    v_mfma_f32_16x16x32_bf16 v[188:191], v[204:207], a[220:223], v[188:191]
    s_waitcnt vmcnt(7) lgkmcnt(6)
    v_mfma_f32_32x32x16_bf16 v[32:47], v[64:67], a[224:227], v[32:47]
    ds_read_b128 v[88:91], v15 offset:55296
    v_mfma_f32_32x32x16_bf16 v[48:63], v[68:71], a[224:227], v[48:63]
    ds_read_b128 v[92:95], v15 offset:56320
    ds_read_b128 v[204:207], v19 offset:16048
    v_mfma_f32_16x16x32_bf16 v[188:191], v[192:195], a[224:227], v[188:191]
    s_waitcnt vmcnt(6) lgkmcnt(6)
    v_mfma_f32_32x32x16_bf16 v[32:47], v[72:75], a[228:231], v[32:47]
    ds_read_b128 v[64:67], v15 offset:57344
    v_mfma_f32_32x32x16_bf16 v[48:63], v[76:79], a[228:231], v[48:63]
    ds_read_b128 v[68:71], v15 offset:58368
    ds_read_b128 v[192:195], v19 offset:16320
    v_mfma_f32_16x16x32_bf16 v[188:191], v[196:199], a[228:231], v[188:191]
    s_waitcnt vmcnt(5) lgkmcnt(6)
    v_mfma_f32_32x32x16_bf16 v[32:47], v[80:83], a[232:235], v[32:47]
    ds_read_b128 v[72:75], v15 offset:59392
    v_mfma_f32_32x32x16_bf16 v[48:63], v[84:87], a[232:235], v[48:63]
    ds_read_b128 v[76:79], v15 offset:60416
    ds_read_b128 v[196:199], v19 offset:16592
    v_mfma_f32_16x16x32_bf16 v[188:191], v[200:203], a[232:235], v[188:191]
    s_waitcnt vmcnt(4) lgkmcnt(6)
    v_mfma_f32_32x32x16_bf16 v[32:47], v[88:91], a[236:239], v[32:47]
    ds_read_b128 v[80:83], v15 offset:61440
    v_mfma_f32_32x32x16_bf16 v[48:63], v[92:95], a[236:239], v[48:63]
    ds_read_b128 v[84:87], v15 offset:62464
    ds_read_b128 v[200:203], v19 offset:16864
    v_mfma_f32_16x16x32_bf16 v[188:191], v[204:207], a[236:239], v[188:191]
    s_waitcnt vmcnt(3) lgkmcnt(6)
    v_mfma_f32_32x32x16_bf16 v[32:47], v[64:67], a[240:243], v[32:47]
    ds_read_b128 v[88:91], v15 offset:63488
    v_mfma_f32_32x32x16_bf16 v[48:63], v[68:71], a[240:243], v[48:63]
    ds_read_b128 v[92:95], v15 offset:64512
    ds_read_b128 v[204:207], v19 offset:17136
    v_mfma_f32_16x16x32_bf16 v[188:191], v[192:195], a[240:243], v[188:191]
    s_waitcnt vmcnt(2) lgkmcnt(6)
    v_mfma_f32_32x32x16_bf16 v[32:47], v[72:75], a[244:247], v[32:47]
    v_mfma_f32_32x32x16_bf16 v[48:63], v[76:79], a[244:247], v[48:63]
    v_mfma_f32_16x16x32_bf16 v[188:191], v[196:199], a[244:247], v[188:191]
    s_waitcnt vmcnt(1) lgkmcnt(3)
    v_mfma_f32_32x32x16_bf16 v[32:47], v[80:83], a[248:251], v[32:47]
    v_mfma_f32_32x32x16_bf16 v[48:63], v[84:87], a[248:251], v[48:63]
    v_mfma_f32_16x16x32_bf16 v[188:191], v[200:203], a[248:251], v[188:191]
    s_waitcnt vmcnt(0) lgkmcnt(0)
    v_mfma_f32_32x32x16_bf16 v[32:47], v[88:91], a[252:255], v[32:47]
    v_mfma_f32_32x32x16_bf16 v[48:63], v[92:95], a[252:255], v[48:63]
    v_mfma_f32_16x16x32_bf16 v[188:191], v[204:207], a[252:255], v[188:191]
    s_nop 7
    s_nop 3
    s_setpc_b64 s[30:31]
L_passR:
    s_waitcnt vmcnt(8)
    s_barrier
    ds_read_b128 v[64:67], v2 offset:0
    ds_read_b128 v[68:71], v2 offset:1024
    ds_read_b128 v[72:75], v2 offset:2048
    ds_read_b128 v[76:79], v2 offset:3072
    ds_read_b128 v[80:83], v2 offset:4096
    ds_read_b128 v[84:87], v2 offset:5120
    s_waitcnt lgkmcnt(4)
    v_mfma_f32_32x32x16_bf16 v[32:47], v[64:67], a[0:3], 0
    ds_read_b128 v[88:91], v2 offset:6144
    s_add_u32 m0, s28, 65536
    s_nop 0
    buffer_load_dwordx4 v6, s[8:11], s24 offen sc1 lds
    v_mfma_f32_32x32x16_bf16 v[48:63], v[68:71], a[0:3], 0
    ds_read_b128 v[92:95], v2 offset:7168
    s_waitcnt lgkmcnt(4)
    v_mfma_f32_32x32x16_bf16 v[32:47], v[72:75], a[4:7], v[32:47]
    ds_read_b128 v[64:67], v2 offset:8192
    buffer_load_dwordx4 v7, s[8:11], s24 offen offset:1024 sc1 lds
    s_add_u32 s24, s24, s25
    v_mfma_f32_32x32x16_bf16 v[48:63], v[76:79], a[4:7], v[48:63]
    ds_read_b128 v[68:71], v2 offset:9216
    s_waitcnt lgkmcnt(4)
    v_mfma_f32_32x32x16_bf16 v[32:47], v[80:83], a[8:11], v[32:47]
    ds_read_b128 v[72:75], v2 offset:10240
    s_add_u32 m0, s28, 73728
    s_nop 0
    buffer_load_dwordx4 v6, s[8:11], s24 offen sc1 lds
    v_mfma_f32_32x32x16_bf16 v[48:63], v[84:87], a[8:11], v[48:63]
    ds_read_b128 v[76:79], v2 offset:11264
    s_waitcnt lgkmcnt(4)
    v_mfma_f32_32x32x16_bf16 v[32:47], v[88:91], a[12:15], v[32:47]
    ds_read_b128 v[80:83], v2 offset:12288
    buffer_load_dwordx4 v7, s[8:11], s24 offen offset:1024 sc1 lds
    s_add_u32 s24, s24, s25
    v_mfma_f32_32x32x16_bf16 v[48:63], v[92:95], a[12:15], v[48:63]
    ds_read_b128 v[84:87], v2 offset:13312
    s_waitcnt lgkmcnt(4)
    v_mfma_f32_32x32x16_bf16 v[32:47], v[64:67], a[16:19], v[32:47]
    ds_read_b128 v[88:91], v2 offset:14336
    s_add_u32 m0, s28, 81920
    s_nop 0
    buffer_load_dwordx4 v6, s[8:11], s24 offen sc1 lds
    v_mfma_f32_32x32x16_bf16 v[48:63], v[68:71], a[16:19], v[48:63]
    ds_read_b128 v[92:95], v2 offset:15360
    s_waitcnt lgkmcnt(4)
    v_mfma_f32_32x32x16_bf16 v[32:47], v[72:75], a[20:23], v[32:47]
    ds_read_b128 v[64:67], v2 offset:16384
    buffer_load_dwordx4 v7, s[8:11], s24 offen offset:1024 sc1 lds
    s_add_u32 s24, s24, s25
    v_mfma_f32_32x32x16_bf16 v[48:63], v[76:79], a[20:23], v[48:63]
    ds_read_b128 v[68:71], v2 offset:17408
    s_waitcnt lgkmcnt(4)
    v_mfma_f32_32x32x16_bf16 v[32:47], v[80:83], a[24:27], v[32:47]
    ds_read_b128 v[72:75], v2 offset:18432
    s_add_u32 m0, s28, 90112
    s_nop 0
    buffer_load_dwordx4 v6, s[8:11], s24 offen sc1 lds
    v_mfma_f32_32x32x16_bf16 v[48:63], v[84:87], a[24:27], v[48:63]
    ds_read_b128 v[76:79], v2 offset:19456
    s_waitcnt lgkmcnt(4)
    v_mfma_f32_32x32x16_bf16 v[32:47], v[88:91], a[28:31], v[32:47]
    ds_read_b128 v[80:83], v2 offset:20480
    buffer_load_dwordx4 v7, s[8:11], s24 offen offset:1024 sc1 lds
    s_add_u32 s24, s24, s25
    v_mfma_f32_32x32x16_bf16 v[48:63], v[92:95], a[28:31], v[48:63]
    ds_read_b128 v[84:87], v2 offset:21504
    s_waitcnt lgkmcnt(4)
    v_mfma_f32_32x32x16_bf16 v[32:47], v[64:67], a[32:35], v[32:47]
    ds_read_b128 v[88:91], v2 offset:22528
    v_mfma_f32_32x32x16_bf16 v[48:63], v[68:71], a[32:35], v[48:63]
    ds_read_b128 v[92:95], v2 offset:23552
    s_waitcnt lgkmcnt(4)
    v_mfma_f32_32x32x16_bf16 v[32:47], v[72:75], a[36:39], v[32:47]
    ds_read_b128 v[64:67], v2 offset:24576
    v_mfma_f32_32x32x16_bf16 v[48:63], v[76:79], a[36:39], v[48:63]
    ds_read_b128 v[68:71], v2 offset:25600
    s_waitcnt lgkmcnt(4)
    v_mfma_f32_32x32x16_bf16 v[32:47], v[80:83], a[40:43], v[32:47]
    ds_read_b128 v[72:75], v2 offset:26624
    v_mfma_f32_32x32x16_bf16 v[48:63], v[84:87], a[40:43], v[48:63]
    ds_read_b128 v[76:79], v2 offset:27648
    s_waitcnt lgkmcnt(4)
    v_mfma_f32_32x32x16_bf16 v[32:47], v[88:91], a[44:47], v[32:47]
    ds_read_b128 v[80:83], v2 offset:28672
    v_mfma_f32_32x32x16_bf16 v[48:63], v[92:95], a[44:47], v[48:63]
    ds_read_b128 v[84:87], v2 offset:29696
    s_waitcnt lgkmcnt(4)
    v_mfma_f32_32x32x16_bf16 v[32:47], v[64:67], a[48:51], v[32:47]
    ds_read_b128 v[88:91], v2 offset:30720
    v_mfma_f32_32x32x16_bf16 v[48:63], v[68:71], a[48:51], v[48:63]
    ds_read_b128 v[92:95], v2 offset:31744
    s_waitcnt vmcnt(8)
    s_barrier
    s_bitcmp1_b32 s63, 0
    s_cbranch_scc1 L_hR1
L_hR1_ret:
    s_waitcnt lgkmcnt(4)
    v_mfma_f32_32x32x16_bf16 v[32:47], v[72:75], a[52:55], v[32:47]
    ds_read_b128 v[64:67], v2 offset:32768
    s_add_u32 m0, s28, 98304
    s_nop 0
    buffer_load_dwordx4 v6, s[8:11], s24 offen sc1 lds
    v_mfma_f32_32x32x16_bf16 v[48:63], v[76:79], a[52:55], v[48:63]
    ds_read_b128 v[68:71], v2 offset:33792
    s_waitcnt lgkmcnt(4)
    v_mfma_f32_32x32x16_bf16 v[32:47], v[80:83], a[56:59], v[32:47]
    ds_read_b128 v[72:75], v2 offset:34816
    v_mfma_f32_32x32x16_bf16 v[48:63], v[84:87], a[56:59], v[48:63]
    ds_read_b128 v[76:79], v2 offset:35840
    s_waitcnt lgkmcnt(4)
    v_mfma_f32_32x32x16_bf16 v[32:47], v[88:91], a[60:63], v[32:47]
    ds_read_b128 v[80:83], v2 offset:36864
    buffer_load_dwordx4 v7, s[8:11], s24 offen offset:1024 sc1 lds
    s_add_u32 s24, s24, s25
    v_mfma_f32_32x32x16_bf16 v[48:63], v[92:95], a[60:63], v[48:63]
    ds_read_b128 v[84:87], v2 offset:37888
    s_waitcnt lgkmcnt(4)
    v_mfma_f32_32x32x16_bf16 v[32:47], v[64:67], a[64:67], v[32:47]
    ds_read_b128 v[88:91], v2 offset:38912
    v_mfma_f32_32x32x16_bf16 v[48:63], v[68:71], a[64:67], v[48:63]
    ds_read_b128 v[92:95], v2 offset:39936
    s_waitcnt lgkmcnt(4)
    v_mfma_f32_32x32x16_bf16 v[32:47], v[72:75], a[68:71], v[32:47]
    ds_read_b128 v[64:67], v2 offset:40960
    s_add_u32 m0, s28, 106496
    s_nop 0
    buffer_load_dwordx4 v6, s[8:11], s24 offen sc1 lds
    v_mfma_f32_32x32x16_bf16 v[48:63], v[76:79], a[68:71], v[48:63]
    ds_read_b128 v[68:71], v2 offset:41984
    s_waitcnt lgkmcnt(4)
    v_mfma_f32_32x32x16_bf16 v[32:47], v[80:83], a[72:75], v[32:47]
    ds_read_b128 v[72:75], v2 offset:43008
    v_mfma_f32_32x32x16_bf16 v[48:63], v[84:87], a[72:75], v[48:63]
    ds_read_b128 v[76:79], v2 offset:44032
    s_waitcnt lgkmcnt(4)
    v_mfma_f32_32x32x16_bf16 v[32:47], v[88:91], a[76:79], v[32:47]
    ds_read_b128 v[80:83], v2 offset:45056
    buffer_load_dwordx4 v7, s[8:11], s24 offen offset:1024 sc1 lds
    s_add_u32 s24, s24, s25
    v_mfma_f32_32x32x16_bf16 v[48:63], v[92:95], a[76:79], v[48:63]
    ds_read_b128 v[84:87], v2 offset:46080
    s_waitcnt lgkmcnt(4)
    v_mfma_f32_32x32x16_bf16 v[32:47], v[64:67], a[80:83], v[32:47]
    ds_read_b128 v[88:91], v2 offset:47104
    v_mfma_f32_32x32x16_bf16 v[48:63], v[68:71], a[80:83], v[48:63]
    ds_read_b128 v[92:95], v2 offset:48128
    s_waitcnt lgkmcnt(4)
    v_mfma_f32_32x32x16_bf16 v[32:47], v[72:75], a[84:87], v[32:47]
    ds_read_b128 v[64:67], v2 offset:49152
    s_add_u32 m0, s28, 114688
    s_nop 0
    buffer_load_dwordx4 v6, s[8:11], s24 offen sc1 lds
    v_mfma_f32_32x32x16_bf16 v[48:63], v[76:79], a[84:87], v[48:63]
    ds_read_b128 v[68:71], v2 offset:50176
    s_waitcnt lgkmcnt(4)
    v_mfma_f32_32x32x16_bf16 v[32:47], v[80:83], a[88:91], v[32:47]
    ds_read_b128 v[72:75], v2 offset:51200
    v_mfma_f32_32x32x16_bf16 v[48:63], v[84:87], a[88:91], v[48:63]
    ds_read_b128 v[76:79], v2 offset:52224
    s_waitcnt lgkmcnt(4)
    v_mfma_f32_32x32x16_bf16 v[32:47], v[88:91], a[92:95], v[32:47]
    ds_read_b128 v[80:83], v2 offset:53248
    buffer_load_dwordx4 v7, s[8:11], s24 offen offset:1024 sc1 lds
    s_add_u32 s24, s24, s25
    v_mfma_f32_32x32x16_bf16 v[48:63], v[92:95], a[92:95], v[48:63]
    ds_read_b128 v[84:87], v2 offset:54272
    s_waitcnt lgkmcnt(4)
    v_mfma_f32_32x32x16_bf16 v[32:47], v[64:67], a[96:99], v[32:47]
    ds_read_b128 v[88:91], v2 offset:55296
    v_mfma_f32_32x32x16_bf16 v[48:63], v[68:71], a[96:99], v[48:63]
    ds_read_b128 v[92:95], v2 offset:56320
    s_waitcnt lgkmcnt(4)
    v_mfma_f32_32x32x16_bf16 v[32:47], v[72:75], a[100:103], v[32:47]
    ds_read_b128 v[64:67], v2 offset:57344
    s_add_u32 m0, s28, 122880
    s_nop 0
    buffer_load_dwordx4 v6, s[8:11], s24 offen sc1 lds
    v_mfma_f32_32x32x16_bf16 v[48:63], v[76:79], a[100:103], v[48:63]
    ds_read_b128 v[68:71], v2 offset:58368
    s_waitcnt lgkmcnt(4)
    v_mfma_f32_32x32x16_bf16 v[32:47], v[80:83], a[104:107], v[32:47]
    ds_read_b128 v[72:75], v2 offset:59392
    v_mfma_f32_32x32x16_bf16 v[48:63], v[84:87], a[104:107], v[48:63]
    ds_read_b128 v[76:79], v2 offset:60416
    s_waitcnt lgkmcnt(4)
    v_mfma_f32_32x32x16_bf16 v[32:47], v[88:91], a[108:111], v[32:47]
    ds_read_b128 v[80:83], v2 offset:61440
    buffer_load_dwordx4 v7, s[8:11], s24 offen offset:1024 sc1 lds
    s_add_u32 s24, s24, s25
    v_mfma_f32_32x32x16_bf16 v[48:63], v[92:95], a[108:111], v[48:63]
    ds_read_b128 v[84:87], v2 offset:62464
    s_waitcnt lgkmcnt(4)
    v_mfma_f32_32x32x16_bf16 v[32:47], v[64:67], a[112:115], v[32:47]
    ds_read_b128 v[88:91], v2 offset:63488
    v_mfma_f32_32x32x16_bf16 v[48:63], v[68:71], a[112:115], v[48:63]
    ds_read_b128 v[92:95], v2 offset:64512
    s_waitcnt vmcnt(8)
    s_barrier
    s_waitcnt lgkmcnt(4)
    v_mfma_f32_32x32x16_bf16 v[32:47], v[72:75], a[116:119], v[32:47]
    ds_read_b128 v[64:67], v15 offset:0
    s_add_u32 m0, s28, 0
    s_nop 0
    buffer_load_dwordx4 v8, s[12:15], s26 offen sc1 lds
    v_mfma_f32_32x32x16_bf16 v[48:63], v[76:79], a[116:119], v[48:63]
    ds_read_b128 v[68:71], v15 offset:1024
    s_waitcnt lgkmcnt(4)
    v_mfma_f32_32x32x16_bf16 v[32:47], v[80:83], a[120:123], v[32:47]
    ds_read_b128 v[72:75], v15 offset:2048
    v_mfma_f32_32x32x16_bf16 v[48:63], v[84:87], a[120:123], v[48:63]
    ds_read_b128 v[76:79], v15 offset:3072
    s_waitcnt lgkmcnt(4)
    v_mfma_f32_32x32x16_bf16 v[32:47], v[88:91], a[124:127], v[32:47]
    ds_read_b128 v[80:83], v15 offset:4096
    buffer_load_dwordx4 v9, s[12:15], s26 offen offset:1024 sc1 lds
    s_add_u32 s26, s26, s27
    v_mfma_f32_32x32x16_bf16 v[48:63], v[92:95], a[124:127], v[48:63]
    ds_read_b128 v[84:87], v15 offset:5120
    s_waitcnt lgkmcnt(4)
    v_mfma_f32_32x32x16_bf16 v[32:47], v[64:67], a[128:131], v[32:47]
    ds_read_b128 v[88:91], v15 offset:6144
    v_mfma_f32_32x32x16_bf16 v[48:63], v[68:71], a[128:131], v[48:63]
    ds_read_b128 v[92:95], v15 offset:7168
    s_waitcnt lgkmcnt(4)
    v_mfma_f32_32x32x16_bf16 v[32:47], v[72:75], a[132:135], v[32:47]
    ds_read_b128 v[64:67], v15 offset:8192
    s_add_u32 m0, s28, 8192
    s_nop 0
    buffer_load_dwordx4 v8, s[12:15], s26 offen sc1 lds
    v_mfma_f32_32x32x16_bf16 v[48:63], v[76:79], a[132:135], v[48:63]
    ds_read_b128 v[68:71], v15 offset:9216
    s_waitcnt lgkmcnt(4)
    v_mfma_f32_32x32x16_bf16 v[32:47], v[80:83], a[136:139], v[32:47]
    ds_read_b128 v[72:75], v15 offset:10240
    v_mfma_f32_32x32x16_bf16 v[48:63], v[84:87], a[136:139], v[48:63]
    ds_read_b128 v[76:79], v15 offset:11264
    s_waitcnt lgkmcnt(4)
    v_mfma_f32_32x32x16_bf16 v[32:47], v[88:91], a[140:143], v[32:47]
    ds_read_b128 v[80:83], v15 offset:12288
    buffer_load_dwordx4 v9, s[12:15], s26 offen offset:1024 sc1 lds
    s_add_u32 s26, s26, s27
    v_mfma_f32_32x32x16_bf16 v[48:63], v[92:95], a[140:143], v[48:63]
    ds_read_b128 v[84:87], v15 offset:13312
    s_waitcnt lgkmcnt(4)
    v_mfma_f32_32x32x16_bf16 v[32:47], v[64:67], a[144:147], v[32:47]
    ds_read_b128 v[88:91], v15 offset:14336
    v_mfma_f32_32x32x16_bf16 v[48:63], v[68:71], a[144:147], v[48:63]
    ds_read_b128 v[92:95], v15 offset:15360
    s_bitcmp1_b32 s63, 0
    s_cbranch_scc0 L_smpR
    buffer_load_dword v18, v17, s[4:7], s29 offen sc1
L_smpR:
    s_waitcnt lgkmcnt(4)
    v_mfma_f32_32x32x16_bf16 v[32:47], v[72:75], a[148:151], v[32:47]
    ds_read_b128 v[64:67], v15 offset:16384
    s_add_u32 m0, s28, 16384
    s_nop 0
    buffer_load_dwordx4 v8, s[12:15], s26 offen sc1 lds
    v_mfma_f32_32x32x16_bf16 v[48:63], v[76:79], a[148:151], v[48:63]
    ds_read_b128 v[68:71], v15 offset:17408
    s_waitcnt lgkmcnt(4)
    v_mfma_f32_32x32x16_bf16 v[32:47], v[80:83], a[152:155], v[32:47]
    ds_read_b128 v[72:75], v15 offset:18432
    v_mfma_f32_32x32x16_bf16 v[48:63], v[84:87], a[152:155], v[48:63]
    ds_read_b128 v[76:79], v15 offset:19456
    s_waitcnt lgkmcnt(4)
    v_mfma_f32_32x32x16_bf16 v[32:47], v[88:91], a[156:159], v[32:47]
    ds_read_b128 v[80:83], v15 offset:20480
    buffer_load_dwordx4 v9, s[12:15], s26 offen offset:1024 sc1 lds
    s_add_u32 s26, s26, s27
    v_mfma_f32_32x32x16_bf16 v[48:63], v[92:95], a[156:159], v[48:63]
    ds_read_b128 v[84:87], v15 offset:21504
    s_waitcnt lgkmcnt(4)
    v_mfma_f32_32x32x16_bf16 v[32:47], v[64:67], a[160:163], v[32:47]
    ds_read_b128 v[88:91], v15 offset:22528
    v_mfma_f32_32x32x16_bf16 v[48:63], v[68:71], a[160:163], v[48:63]
    ds_read_b128 v[92:95], v15 offset:23552
    s_waitcnt lgkmcnt(4)
    v_mfma_f32_32x32x16_bf16 v[32:47], v[72:75], a[164:167], v[32:47]
    ds_read_b128 v[64:67], v15 offset:24576
    s_add_u32 m0, s28, 24576
    s_nop 0
    buffer_load_dwordx4 v8, s[12:15], s26 offen sc1 lds
    v_mfma_f32_32x32x16_bf16 v[48:63], v[76:79], a[164:167], v[48:63]
    ds_read_b128 v[68:71], v15 offset:25600
    s_waitcnt lgkmcnt(4)
    v_mfma_f32_32x32x16_bf16 v[32:47], v[80:83], a[168:171], v[32:47]
    ds_read_b128 v[72:75], v15 offset:26624
    v_mfma_f32_32x32x16_bf16 v[48:63], v[84:87], a[168:171], v[48:63]
    ds_read_b128 v[76:79], v15 offset:27648
    s_waitcnt lgkmcnt(4)
    v_mfma_f32_32x32x16_bf16 v[32:47], v[88:91], a[172:175], v[32:47]
    ds_read_b128 v[80:83], v15 offset:28672
    buffer_load_dwordx4 v9, s[12:15], s26 offen offset:1024 sc1 lds
    s_add_u32 s26, s26, s27
    v_mfma_f32_32x32x16_bf16 v[48:63], v[92:95], a[172:175], v[48:63]
    ds_read_b128 v[84:87], v15 offset:29696
    s_waitcnt lgkmcnt(4)
    v_mfma_f32_32x32x16_bf16 v[32:47], v[64:67], a[176:179], v[32:47]
    ds_read_b128 v[88:91], v15 offset:30720
    v_mfma_f32_32x32x16_bf16 v[48:63], v[68:71], a[176:179], v[48:63]
    ds_read_b128 v[92:95], v15 offset:31744
    s_waitcnt vmcnt(8)
    s_barrier
    s_bitcmp1_b32 s63, 0
    s_cbranch_scc1 L_hR2
L_hR2_ret:
    s_waitcnt lgkmcnt(4)
    v_mfma_f32_32x32x16_bf16 v[32:47], v[72:75], a[180:183], v[32:47]
    ds_read_b128 v[64:67], v15 offset:32768
    s_add_u32 m0, s28, 32768
    s_nop 0
    buffer_load_dwordx4 v8, s[12:15], s26 offen sc1 lds
    v_mfma_f32_32x32x16_bf16 v[48:63], v[76:79], a[180:183], v[48:63]
    ds_read_b128 v[68:71], v15 offset:33792
    s_waitcnt lgkmcnt(4)
    v_mfma_f32_32x32x16_bf16 v[32:47], v[80:83], a[184:187], v[32:47]
    ds_read_b128 v[72:75], v15 offset:34816
    v_mfma_f32_32x32x16_bf16 v[48:63], v[84:87], a[184:187], v[48:63]
    ds_read_b128 v[76:79], v15 offset:35840
    s_waitcnt lgkmcnt(4)
    v_mfma_f32_32x32x16_bf16 v[32:47], v[88:91], a[188:191], v[32:47]
    ds_read_b128 v[80:83], v15 offset:36864
    buffer_load_dwordx4 v9, s[12:15], s26 offen offset:1024 sc1 lds
    s_add_u32 s26, s26, s27
    v_mfma_f32_32x32x16_bf16 v[48:63], v[92:95], a[188:191], v[48:63]
    ds_read_b128 v[84:87], v15 offset:37888
    s_waitcnt lgkmcnt(4)
    v_mfma_f32_32x32x16_bf16 v[32:47], v[64:67], a[192:195], v[32:47]
    ds_read_b128 v[88:91], v15 offset:38912
    v_mfma_f32_32x32x16_bf16 v[48:63], v[68:71], a[192:195], v[48:63]
    ds_read_b128 v[92:95], v15 offset:39936
    s_waitcnt lgkmcnt(4)
    v_mfma_f32_32x32x16_bf16 v[32:47], v[72:75], a[196:199], v[32:47]
    ds_read_b128 v[64:67], v15 offset:40960
    s_add_u32 m0, s28, 40960
    s_nop 0
    buffer_load_dwordx4 v8, s[12:15], s26 offen sc1 lds
    v_mfma_f32_32x32x16_bf16 v[48:63], v[76:79], a[196:199], v[48:63]
    ds_read_b128 v[68:71], v15 offset:41984
    s_waitcnt lgkmcnt(4)
    v_mfma_f32_32x32x16_bf16 v[32:47], v[80:83], a[200:203], v[32:47]
    ds_read_b128 v[72:75], v15 offset:43008
    v_mfma_f32_32x32x16_bf16 v[48:63], v[84:87], a[200:203], v[48:63]
    ds_read_b128 v[76:79], v15 offset:44032
    s_waitcnt lgkmcnt(4)
    v_mfma_f32_32x32x16_bf16 v[32:47], v[88:91], a[204:207], v[32:47]
    ds_read_b128 v[80:83], v15 offset:45056
    buffer_load_dwordx4 v9, s[12:15], s26 offen offset:1024 sc1 lds
    s_add_u32 s26, s26, s27
    v_mfma_f32_32x32x16_bf16 v[48:63], v[92:95], a[204:207], v[48:63]
    ds_read_b128 v[84:87], v15 offset:46080
    s_waitcnt lgkmcnt(4)
    v_mfma_f32_32x32x16_bf16 v[32:47], v[64:67], a[208:211], v[32:47]
    ds_read_b128 v[88:91], v15 offset:47104
    v_mfma_f32_32x32x16_bf16 v[48:63], v[68:71], a[208:211], v[48:63]
    ds_read_b128 v[92:95], v15 offset:48128
    s_waitcnt lgkmcnt(4)
    v_mfma_f32_32x32x16_bf16 v[32:47], v[72:75], a[212:215], v[32:47]
    ds_read_b128 v[64:67], v15 offset:49152
    s_add_u32 m0, s28, 49152
    s_nop 0
    buffer_load_dwordx4 v8, s[12:15], s26 offen sc1 lds
    v_mfma_f32_32x32x16_bf16 v[48:63], v[76:79], a[212:215], v[48:63]
    ds_read_b128 v[68:71], v15 offset:50176
    s_waitcnt lgkmcnt(4)
    v_mfma_f32_32x32x16_bf16 v[32:47], v[80:83], a[216:219], v[32:47]
    ds_read_b128 v[72:75], v15 offset:51200
    v_mfma_f32_32x32x16_bf16 v[48:63], v[84:87], a[216:219], v[48:63]
    ds_read_b128 v[76:79], v15 offset:52224
    s_waitcnt lgkmcnt(4)
    v_mfma_f32_32x32x16_bf16 v[32:47], v[88:91], a[220:223], v[32:47]
    ds_read_b128 v[80:83], v15 offset:53248
    buffer_load_dwordx4 v9, s[12:15], s26 offen offset:1024 sc1 lds
    s_add_u32 s26, s26, s27
    v_mfma_f32_32x32x16_bf16 v[48:63], v[92:95], a[220:223], v[48:63]
    ds_read_b128 v[84:87], v15 offset:54272
    s_waitcnt lgkmcnt(4)
    v_mfma_f32_32x32x16_bf16 v[32:47], v[64:67], a[224:227], v[32:47]
    ds_read_b128 v[88:91], v15 offset:55296
    v_mfma_f32_32x32x16_bf16 v[48:63], v[68:71], a[224:227], v[48:63]
    ds_read_b128 v[92:95], v15 offset:56320
    s_waitcnt lgkmcnt(4)
    v_mfma_f32_32x32x16_bf16 v[32:47], v[72:75], a[228:231], v[32:47]
    ds_read_b128 v[64:67], v15 offset:57344
    s_add_u32 m0, s28, 57344
    s_nop 0
    buffer_load_dwordx4 v8, s[12:15], s26 offen sc1 lds
    v_mfma_f32_32x32x16_bf16 v[48:63], v[76:79], a[228:231], v[48:63]
    ds_read_b128 v[68:71], v15 offset:58368
    s_bitcmp1_b32 s63, 0
    s_cbranch_scc1 L_hR3
L_hR3_ret:
    s_waitcnt lgkmcnt(4)
    v_mfma_f32_32x32x16_bf16 v[32:47], v[80:83], a[232:235], v[32:47]
    ds_read_b128 v[72:75], v15 offset:59392
    v_mfma_f32_32x32x16_bf16 v[48:63], v[84:87], a[232:235], v[48:63]
    ds_read_b128 v[76:79], v15 offset:60416
    s_waitcnt lgkmcnt(4)
    v_mfma_f32_32x32x16_bf16 v[32:47], v[88:91], a[236:239], v[32:47]
    ds_read_b128 v[80:83], v15 offset:61440
    buffer_load_dwordx4 v9, s[12:15], s26 offen offset:1024 sc1 lds
    s_add_u32 s26, s26, s27
    v_mfma_f32_32x32x16_bf16 v[48:63], v[92:95], a[236:239], v[48:63]
    ds_read_b128 v[84:87], v15 offset:62464
    s_waitcnt lgkmcnt(4)
    v_mfma_f32_32x32x16_bf16 v[32:47], v[64:67], a[240:243], v[32:47]
    ds_read_b128 v[88:91], v15 offset:63488
    v_mfma_f32_32x32x16_bf16 v[48:63], v[68:71], a[240:243], v[48:63]
    ds_read_b128 v[92:95], v15 offset:64512
    s_waitcnt lgkmcnt(4)
    v_mfma_f32_32x32x16_bf16 v[32:47], v[72:75], a[244:247], v[32:47]
    v_mfma_f32_32x32x16_bf16 v[48:63], v[76:79], a[244:247], v[48:63]
    s_waitcnt lgkmcnt(2)
    v_mfma_f32_32x32x16_bf16 v[32:47], v[80:83], a[248:251], v[32:47]
    v_mfma_f32_32x32x16_bf16 v[48:63], v[84:87], a[248:251], v[48:63]
    s_waitcnt lgkmcnt(0)
    v_mfma_f32_32x32x16_bf16 v[32:47], v[88:91], a[252:255], v[32:47]
    v_mfma_f32_32x32x16_bf16 v[48:63], v[92:95], a[252:255], v[48:63]
    s_nop 7
    s_nop 3
    s_setpc_b64 s[30:31]
L_passV:
    s_waitcnt vmcnt(8)
    s_barrier
    ds_read_b128 v[64:67], v2 offset:0
    ds_read_b128 v[68:71], v2 offset:1024
    ds_read_b128 v[72:75], v2 offset:2048
    ds_read_b128 v[76:79], v2 offset:3072
    ds_read_b128 v[80:83], v2 offset:4096
    ds_read_b128 v[84:87], v2 offset:5120
    s_waitcnt lgkmcnt(4)
    v_mfma_f32_32x32x16_bf16 v[32:47], v[64:67], a[0:3], 0
    ds_read_b128 v[88:91], v2 offset:6144
    s_add_u32 m0, s28, 65536
    s_nop 0
    buffer_load_dwordx4 v6, s[8:11], s24 offen sc1 lds
    v_mfma_f32_32x32x16_bf16 v[148:163], v[132:135], v[116:119], 0
    v_mfma_f32_32x32x16_bf16 v[48:63], v[68:71], a[0:3], 0
    ds_read_b128 v[92:95], v2 offset:7168
    v_mfma_f32_32x32x16_bf16 v[148:163], v[136:139], v[120:123], v[148:163]
    s_waitcnt lgkmcnt(4)
    v_mfma_f32_32x32x16_bf16 v[32:47], v[72:75], a[4:7], v[32:47]
    ds_read_b128 v[64:67], v2 offset:8192
    buffer_load_dwordx4 v7, s[8:11], s24 offen offset:1024 sc1 lds
    s_add_u32 s24, s24, s25
    v_mfma_f32_32x32x16_bf16 v[48:63], v[76:79], a[4:7], v[48:63]
    ds_read_b128 v[68:71], v2 offset:9216
    v_mfma_f32_32x32x16_bf16 v[164:179], v[140:143], v[124:127], 0
    s_waitcnt lgkmcnt(4)
    v_mfma_f32_32x32x16_bf16 v[32:47], v[80:83], a[8:11], v[32:47]
    ds_read_b128 v[72:75], v2 offset:10240
    s_add_u32 m0, s28, 73728
    s_nop 0
    buffer_load_dwordx4 v6, s[8:11], s24 offen sc1 lds
    v_mfma_f32_32x32x16_bf16 v[48:63], v[84:87], a[8:11], v[48:63]
    ds_read_b128 v[76:79], v2 offset:11264
    v_mfma_f32_32x32x16_bf16 v[164:179], v[144:147], v[128:131], v[164:179]
    s_waitcnt lgkmcnt(4)
    v_mfma_f32_32x32x16_bf16 v[32:47], v[88:91], a[12:15], v[32:47]
    ds_read_b128 v[80:83], v2 offset:12288
    buffer_load_dwordx4 v7, s[8:11], s24 offen offset:1024 sc1 lds
    s_add_u32 s24, s24, s25
    v_mfma_f32_32x32x16_bf16 v[48:63], v[92:95], a[12:15], v[48:63]
    ds_read_b128 v[84:87], v2 offset:13312
    v_and_b32 v236, 1, v1
    v_bfe_u32 v237, v1, 2, 2
    v_lshl_add_u32 v236, v237, 1, v236
    s_waitcnt lgkmcnt(4)
    v_mfma_f32_32x32x16_bf16 v[32:47], v[64:67], a[16:19], v[32:47]
    ds_read_b128 v[88:91], v2 offset:14336
    s_add_u32 m0, s28, 81920
    s_nop 0
    buffer_load_dwordx4 v6, s[8:11], s24 offen sc1 lds
    v_bfe_u32 v237, v1, 1, 1
    v_lshl_add_u32 v236, v237, 3, v236
    v_lshrrev_b32 v237, 5, v1
    v_xor_b32 v236, v236, v237
    v_mfma_f32_32x32x16_bf16 v[48:63], v[68:71], a[16:19], v[48:63]
    ds_read_b128 v[92:95], v2 offset:15360
    v_and_b32 v237, 31, v1
    s_lshl_b32 s40, s3, 12
    s_add_u32 s40, s40, 65536
    v_lshl_add_u32 v237, v237, 7, s40
    s_waitcnt lgkmcnt(4)
    v_mfma_f32_32x32x16_bf16 v[32:47], v[72:75], a[20:23], v[32:47]
    ds_read_b128 v[64:67], v2 offset:16384
    buffer_load_dwordx4 v7, s[8:11], s24 offen offset:1024 sc1 lds
    s_add_u32 s24, s24, s25
    v_xor_b32 v104, 0, v236
    v_lshl_add_u32 v104, v104, 3, v237
    v_xor_b32 v105, 2, v236
    v_max3_f32 v196, v148, v149, v150
    v_min3_f32 v198, v148, v149, v150
    v_mfma_f32_32x32x16_bf16 v[48:63], v[76:79], a[20:23], v[48:63]
    ds_read_b128 v[68:71], v2 offset:17408
    v_max3_f32 v196, v196, v151, v152
    v_min3_f32 v198, v198, v151, v152
    v_max3_f32 v196, v196, v153, v154
    v_min3_f32 v198, v198, v153, v154
    s_waitcnt lgkmcnt(4)
    v_mfma_f32_32x32x16_bf16 v[32:47], v[80:83], a[24:27], v[32:47]
    ds_read_b128 v[72:75], v2 offset:18432
    s_add_u32 m0, s28, 90112
    s_nop 0
    buffer_load_dwordx4 v6, s[8:11], s24 offen sc1 lds
    v_max3_f32 v196, v196, v155, v156
    v_min3_f32 v198, v198, v155, v156
    v_max3_f32 v196, v196, v157, v158
    v_min3_f32 v198, v198, v157, v158
    v_mfma_f32_32x32x16_bf16 v[48:63], v[84:87], a[24:27], v[48:63]
    ds_read_b128 v[76:79], v2 offset:19456
    v_max3_f32 v196, v196, v159, v160
    v_min3_f32 v198, v198, v159, v160
    v_max3_f32 v196, v196, v161, v162
    v_min3_f32 v198, v198, v161, v162
    v_max_f32 v196, v196, v163
    s_waitcnt lgkmcnt(4)
    v_mfma_f32_32x32x16_bf16 v[32:47], v[88:91], a[28:31], v[32:47]
    ds_read_b128 v[80:83], v2 offset:20480
    buffer_load_dwordx4 v7, s[8:11], s24 offen offset:1024 sc1 lds
    s_add_u32 s24, s24, s25
    v_min_f32 v198, v198, v163
    v_mov_b32 v200, v196
    v_mov_b32 v201, v198
    s_nop 0
    v_mfma_f32_32x32x16_bf16 v[48:63], v[92:95], a[28:31], v[48:63]
    ds_read_b128 v[84:87], v2 offset:21504
    v_permlane32_swap_b32 v200, v196
    v_permlane32_swap_b32 v201, v198
    v_max_f32 v196, v200, v196
    v_min_f32 v198, v201, v198
    s_waitcnt lgkmcnt(4)
    v_mfma_f32_32x32x16_bf16 v[32:47], v[64:67], a[32:35], v[32:47]
    ds_read_b128 v[88:91], v2 offset:22528
    v_sub_f32 v180, v198, v148
    v_sub_f32 v148, v148, v196
    v_exp_f32 v180, v180
    v_exp_f32 v148, v148
    v_mfma_f32_32x32x16_bf16 v[48:63], v[68:71], a[32:35], v[48:63]
    ds_read_b128 v[92:95], v2 offset:23552
    v_sub_f32 v181, v198, v149
    v_sub_f32 v149, v149, v196
    v_exp_f32 v181, v181
    s_waitcnt lgkmcnt(4)
    v_mfma_f32_32x32x16_bf16 v[32:47], v[72:75], a[36:39], v[32:47]
    ds_read_b128 v[64:67], v2 offset:24576
    v_exp_f32 v149, v149
    v_sub_f32 v182, v198, v150
    v_mfma_f32_32x32x16_bf16 v[48:63], v[76:79], a[36:39], v[48:63]
    ds_read_b128 v[68:71], v2 offset:25600
    v_sub_f32 v150, v150, v196
    v_exp_f32 v182, v182
    v_exp_f32 v150, v150
    s_waitcnt lgkmcnt(4)
    v_mfma_f32_32x32x16_bf16 v[32:47], v[80:83], a[40:43], v[32:47]
    ds_read_b128 v[72:75], v2 offset:26624
    v_sub_f32 v183, v198, v151
    v_sub_f32 v151, v151, v196
    v_exp_f32 v183, v183
    v_mfma_f32_32x32x16_bf16 v[48:63], v[84:87], a[40:43], v[48:63]
    ds_read_b128 v[76:79], v2 offset:27648
    v_exp_f32 v151, v151
    v_sub_f32 v184, v198, v152
    v_sub_f32 v152, v152, v196
    s_waitcnt lgkmcnt(4)
    v_mfma_f32_32x32x16_bf16 v[32:47], v[88:91], a[44:47], v[32:47]
    ds_read_b128 v[80:83], v2 offset:28672
    v_exp_f32 v184, v184
    v_exp_f32 v152, v152
    v_mfma_f32_32x32x16_bf16 v[48:63], v[92:95], a[44:47], v[48:63]
    ds_read_b128 v[84:87], v2 offset:29696
    v_sub_f32 v185, v198, v153
    v_sub_f32 v153, v153, v196
    v_exp_f32 v185, v185
    v_exp_f32 v153, v153
    s_waitcnt lgkmcnt(4)
    v_mfma_f32_32x32x16_bf16 v[32:47], v[64:67], a[48:51], v[32:47]
    ds_read_b128 v[88:91], v2 offset:30720
    v_sub_f32 v186, v198, v154
    v_sub_f32 v154, v154, v196
    v_exp_f32 v186, v186
    v_mfma_f32_32x32x16_bf16 v[48:63], v[68:71], a[48:51], v[48:63]
    ds_read_b128 v[92:95], v2 offset:31744
    v_exp_f32 v154, v154
    v_sub_f32 v187, v198, v155
    s_waitcnt vmcnt(8)
    s_barrier
    s_waitcnt lgkmcnt(4)
    v_mfma_f32_32x32x16_bf16 v[32:47], v[72:75], a[52:55], v[32:47]
    ds_read_b128 v[64:67], v2 offset:32768
    s_add_u32 m0, s28, 98304
    s_nop 0
    buffer_load_dwordx4 v6, s[8:11], s24 offen sc1 lds
    v_sub_f32 v155, v155, v196
    v_exp_f32 v187, v187
    v_exp_f32 v155, v155
    v_mfma_f32_32x32x16_bf16 v[48:63], v[76:79], a[52:55], v[48:63]
    ds_read_b128 v[68:71], v2 offset:33792
    v_sub_f32 v188, v198, v156
    v_sub_f32 v156, v156, v196
    v_exp_f32 v188, v188
    s_waitcnt lgkmcnt(4)
    v_mfma_f32_32x32x16_bf16 v[32:47], v[80:83], a[56:59], v[32:47]
    ds_read_b128 v[72:75], v2 offset:34816
    v_exp_f32 v156, v156
    v_sub_f32 v189, v198, v157
    v_sub_f32 v157, v157, v196
    v_mfma_f32_32x32x16_bf16 v[48:63], v[84:87], a[56:59], v[48:63]
    ds_read_b128 v[76:79], v2 offset:35840
    v_exp_f32 v189, v189
    v_exp_f32 v157, v157
    s_waitcnt lgkmcnt(4)
    v_mfma_f32_32x32x16_bf16 v[32:47], v[88:91], a[60:63], v[32:47]
    ds_read_b128 v[80:83], v2 offset:36864
    buffer_load_dwordx4 v7, s[8:11], s24 offen offset:1024 sc1 lds
    s_add_u32 s24, s24, s25
    v_sub_f32 v190, v198, v158
    v_sub_f32 v158, v158, v196
    v_exp_f32 v190, v190
    v_exp_f32 v158, v158
    v_mfma_f32_32x32x16_bf16 v[48:63], v[92:95], a[60:63], v[48:63]
    ds_read_b128 v[84:87], v2 offset:37888
    v_sub_f32 v191, v198, v159
    v_sub_f32 v159, v159, v196
    v_exp_f32 v191, v191
    s_waitcnt lgkmcnt(4)
    v_mfma_f32_32x32x16_bf16 v[32:47], v[64:67], a[64:67], v[32:47]
    ds_read_b128 v[88:91], v2 offset:38912
    v_exp_f32 v159, v159
    v_sub_f32 v192, v198, v160
    v_mfma_f32_32x32x16_bf16 v[48:63], v[68:71], a[64:67], v[48:63]
    ds_read_b128 v[92:95], v2 offset:39936
    v_sub_f32 v160, v160, v196
    v_exp_f32 v192, v192
    v_exp_f32 v160, v160
    s_waitcnt lgkmcnt(4)
    v_mfma_f32_32x32x16_bf16 v[32:47], v[72:75], a[68:71], v[32:47]
    ds_read_b128 v[64:67], v2 offset:40960
    s_add_u32 m0, s28, 106496
    s_nop 0
    buffer_load_dwordx4 v6, s[8:11], s24 offen sc1 lds
    v_sub_f32 v193, v198, v161
    v_sub_f32 v161, v161, v196
    v_exp_f32 v193, v193
    v_mfma_f32_32x32x16_bf16 v[48:63], v[76:79], a[68:71], v[48:63]
    ds_read_b128 v[68:71], v2 offset:41984
    v_exp_f32 v161, v161
    v_sub_f32 v194, v198, v162
    v_sub_f32 v162, v162, v196
    s_waitcnt lgkmcnt(4)
    v_mfma_f32_32x32x16_bf16 v[32:47], v[80:83], a[72:75], v[32:47]
    ds_read_b128 v[72:75], v2 offset:43008
    v_exp_f32 v194, v194
    v_exp_f32 v162, v162
    v_mfma_f32_32x32x16_bf16 v[48:63], v[84:87], a[72:75], v[48:63]
    ds_read_b128 v[76:79], v2 offset:44032
    v_sub_f32 v195, v198, v163
    v_sub_f32 v163, v163, v196
    v_exp_f32 v195, v195
    v_exp_f32 v163, v163
    s_waitcnt lgkmcnt(4)
    v_mfma_f32_32x32x16_bf16 v[32:47], v[88:91], a[76:79], v[32:47]
    ds_read_b128 v[80:83], v2 offset:45056
    buffer_load_dwordx4 v7, s[8:11], s24 offen offset:1024 sc1 lds
    s_add_u32 s24, s24, s25
    v_add_f32 v196, v148, v149
    v_add_f32 v198, v180, v181
    v_add_f32 v196, v196, v150
    v_mfma_f32_32x32x16_bf16 v[48:63], v[92:95], a[76:79], v[48:63]
    ds_read_b128 v[84:87], v2 offset:46080
    v_add_f32 v198, v198, v182
    v_add_f32 v196, v196, v151
    v_add_f32 v198, v198, v183
    v_add_f32 v196, v196, v152
    s_waitcnt lgkmcnt(4)
    v_mfma_f32_32x32x16_bf16 v[32:47], v[64:67], a[80:83], v[32:47]
    ds_read_b128 v[88:91], v2 offset:47104
    v_add_f32 v198, v198, v184
    v_add_f32 v196, v196, v153
    v_add_f32 v198, v198, v185
    v_add_f32 v196, v196, v154
    v_add_f32 v198, v198, v186
    v_mfma_f32_32x32x16_bf16 v[48:63], v[68:71], a[80:83], v[48:63]
    ds_read_b128 v[92:95], v2 offset:48128
    v_add_f32 v196, v196, v155
    v_add_f32 v198, v198, v187
    v_add_f32 v196, v196, v156
    v_add_f32 v198, v198, v188
    s_waitcnt lgkmcnt(4)
    v_mfma_f32_32x32x16_bf16 v[32:47], v[72:75], a[84:87], v[32:47]
    ds_read_b128 v[64:67], v2 offset:49152
    s_add_u32 m0, s28, 114688
    s_nop 0
    buffer_load_dwordx4 v6, s[8:11], s24 offen sc1 lds
    v_add_f32 v196, v196, v157
    v_add_f32 v198, v198, v189
    v_add_f32 v196, v196, v158
    v_add_f32 v198, v198, v190
    v_mfma_f32_32x32x16_bf16 v[48:63], v[76:79], a[84:87], v[48:63]
    ds_read_b128 v[68:71], v2 offset:50176
    v_add_f32 v196, v196, v159
    v_add_f32 v198, v198, v191
    v_add_f32 v196, v196, v160
    v_add_f32 v198, v198, v192
    s_waitcnt lgkmcnt(4)
    v_mfma_f32_32x32x16_bf16 v[32:47], v[80:83], a[88:91], v[32:47]
    ds_read_b128 v[72:75], v2 offset:51200
    v_add_f32 v196, v196, v161
    v_add_f32 v198, v198, v193
    v_add_f32 v196, v196, v162
    v_add_f32 v198, v198, v194
    v_add_f32 v196, v196, v163
    v_mfma_f32_32x32x16_bf16 v[48:63], v[84:87], a[88:91], v[48:63]
    ds_read_b128 v[76:79], v2 offset:52224
    v_add_f32 v198, v198, v195
    v_mov_b32 v200, v196
    v_mov_b32 v201, v198
    s_nop 0
    s_waitcnt lgkmcnt(4)
    v_mfma_f32_32x32x16_bf16 v[32:47], v[88:91], a[92:95], v[32:47]
    ds_read_b128 v[80:83], v2 offset:53248
    buffer_load_dwordx4 v7, s[8:11], s24 offen offset:1024 sc1 lds
    s_add_u32 s24, s24, s25
    v_permlane32_swap_b32 v200, v196
    v_permlane32_swap_b32 v201, v198
    v_add_f32 v196, v200, v196
    v_add_f32 v198, v201, v198
    v_mfma_f32_32x32x16_bf16 v[48:63], v[92:95], a[92:95], v[48:63]
    ds_read_b128 v[84:87], v2 offset:54272
    v_rcp_f32 v196, v196
    v_rcp_f32 v198, v198
    v_mul_f32 v148, v148, v196
    s_waitcnt lgkmcnt(4)
    v_mfma_f32_32x32x16_bf16 v[32:47], v[64:67], a[96:99], v[32:47]
    ds_read_b128 v[88:91], v2 offset:55296
    v_mul_f32 v149, v149, v196
    v_mul_f32 v150, v150, v196
    v_mul_f32 v151, v151, v196
    v_mul_f32 v152, v152, v196
    v_mfma_f32_32x32x16_bf16 v[48:63], v[68:71], a[96:99], v[48:63]
    ds_read_b128 v[92:95], v2 offset:56320
    v_mul_f32 v153, v153, v196
    v_mul_f32 v154, v154, v196
    v_mul_f32 v155, v155, v196
    v_mul_f32 v156, v156, v196
    s_waitcnt lgkmcnt(4)
    v_mfma_f32_32x32x16_bf16 v[32:47], v[72:75], a[100:103], v[32:47]
    ds_read_b128 v[64:67], v2 offset:57344
    s_add_u32 m0, s28, 122880
    s_nop 0
    buffer_load_dwordx4 v6, s[8:11], s24 offen sc1 lds
    v_mul_f32 v157, v157, v196
    v_mul_f32 v158, v158, v196
    v_mul_f32 v159, v159, v196
    v_mul_f32 v160, v160, v196
    v_mul_f32 v161, v161, v196
    v_mfma_f32_32x32x16_bf16 v[48:63], v[76:79], a[100:103], v[48:63]
    ds_read_b128 v[68:71], v2 offset:58368
    v_mul_f32 v162, v162, v196
    v_mul_f32 v163, v163, v196
    v_cvt_pk_bf16_f32 v204, v148, v149
    v_cvt_pk_bf16_f32 v205, v150, v151
    s_waitcnt lgkmcnt(4)
    v_mfma_f32_32x32x16_bf16 v[32:47], v[80:83], a[104:107], v[32:47]
    ds_read_b128 v[72:75], v2 offset:59392
    v_cvt_pk_bf16_f32 v206, v152, v153
    v_cvt_pk_bf16_f32 v207, v154, v155
    v_cvt_pk_bf16_f32 v208, v156, v157
    v_cvt_pk_bf16_f32 v209, v158, v159
    v_mfma_f32_32x32x16_bf16 v[48:63], v[84:87], a[104:107], v[48:63]
    ds_read_b128 v[76:79], v2 offset:60416
    v_cvt_pk_bf16_f32 v210, v160, v161
    v_cvt_pk_bf16_f32 v211, v162, v163
    v_mul_f32 v180, v180, v198
    v_mul_f32 v181, v181, v198
    s_waitcnt lgkmcnt(4)
    v_mfma_f32_32x32x16_bf16 v[32:47], v[88:91], a[108:111], v[32:47]
    ds_read_b128 v[80:83], v2 offset:61440
    buffer_load_dwordx4 v7, s[8:11], s24 offen offset:1024 sc1 lds
    s_add_u32 s24, s24, s25
    v_mul_f32 v182, v182, v198
    v_mul_f32 v183, v183, v198
    v_mul_f32 v184, v184, v198
    v_mul_f32 v185, v185, v198
    v_mul_f32 v186, v186, v198
    v_mfma_f32_32x32x16_bf16 v[48:63], v[92:95], a[108:111], v[48:63]
    ds_read_b128 v[84:87], v2 offset:62464
    v_mul_f32 v187, v187, v198
    v_mul_f32 v188, v188, v198
    v_mul_f32 v189, v189, v198
    v_mul_f32 v190, v190, v198
    s_waitcnt lgkmcnt(4)
    v_mfma_f32_32x32x16_bf16 v[32:47], v[64:67], a[112:115], v[32:47]
    ds_read_b128 v[88:91], v2 offset:63488
    v_mul_f32 v191, v191, v198
    v_mul_f32 v192, v192, v198
    v_mul_f32 v193, v193, v198
    v_mul_f32 v194, v194, v198
    v_mfma_f32_32x32x16_bf16 v[48:63], v[68:71], a[112:115], v[48:63]
    ds_read_b128 v[92:95], v2 offset:64512
    v_mul_f32 v195, v195, v198
    v_cvt_pk_bf16_f32 v212, v180, v181
    v_cvt_pk_bf16_f32 v213, v182, v183
    v_cvt_pk_bf16_f32 v214, v184, v185
    v_cvt_pk_bf16_f32 v215, v186, v187
    s_waitcnt vmcnt(8)
    s_barrier
    s_waitcnt lgkmcnt(4)
    v_mfma_f32_32x32x16_bf16 v[32:47], v[72:75], a[116:119], v[32:47]
    ds_read_b128 v[64:67], v15 offset:0
    s_add_u32 m0, s28, 0
    s_nop 0
    buffer_load_dwordx4 v8, s[12:15], s26 offen sc1 lds
    v_cvt_pk_bf16_f32 v216, v188, v189
    v_cvt_pk_bf16_f32 v217, v190, v191
    v_cvt_pk_bf16_f32 v218, v192, v193
    v_cvt_pk_bf16_f32 v219, v194, v195
    v_mfma_f32_32x32x16_bf16 v[48:63], v[76:79], a[116:119], v[48:63]
    ds_read_b128 v[68:71], v15 offset:1024
    v_max3_f32 v196, v164, v165, v166
    v_min3_f32 v198, v164, v165, v166
    v_max3_f32 v196, v196, v167, v168
    v_min3_f32 v198, v198, v167, v168
    s_waitcnt lgkmcnt(4)
    v_mfma_f32_32x32x16_bf16 v[32:47], v[80:83], a[120:123], v[32:47]
    ds_read_b128 v[72:75], v15 offset:2048
    v_max3_f32 v196, v196, v169, v170
    v_min3_f32 v198, v198, v169, v170
    v_max3_f32 v196, v196, v171, v172
    v_min3_f32 v198, v198, v171, v172
    v_mfma_f32_32x32x16_bf16 v[48:63], v[84:87], a[120:123], v[48:63]
    ds_read_b128 v[76:79], v15 offset:3072
    v_max3_f32 v196, v196, v173, v174
    v_min3_f32 v198, v198, v173, v174
    v_max3_f32 v196, v196, v175, v176
    v_min3_f32 v198, v198, v175, v176
    v_max3_f32 v196, v196, v177, v178
    s_waitcnt lgkmcnt(4)
    v_mfma_f32_32x32x16_bf16 v[32:47], v[88:91], a[124:127], v[32:47]
    ds_read_b128 v[80:83], v15 offset:4096
    buffer_load_dwordx4 v9, s[12:15], s26 offen offset:1024 sc1 lds
    s_add_u32 s26, s26, s27
    v_min3_f32 v198, v198, v177, v178
    v_max_f32 v196, v196, v179
    v_min_f32 v198, v198, v179
    v_mov_b32 v200, v196
    v_mfma_f32_32x32x16_bf16 v[48:63], v[92:95], a[124:127], v[48:63]
    ds_read_b128 v[84:87], v15 offset:5120
    v_mov_b32 v201, v198
    s_nop 0
    v_permlane32_swap_b32 v200, v196
    v_permlane32_swap_b32 v201, v198
    s_waitcnt lgkmcnt(4)
    v_mfma_f32_32x32x16_bf16 v[32:47], v[64:67], a[128:131], v[32:47]
    ds_read_b128 v[88:91], v15 offset:6144
    v_max_f32 v196, v200, v196
    v_min_f32 v198, v201, v198
    v_sub_f32 v180, v198, v164
    v_sub_f32 v164, v164, v196
    v_exp_f32 v180, v180
    v_mfma_f32_32x32x16_bf16 v[48:63], v[68:71], a[128:131], v[48:63]
    ds_read_b128 v[92:95], v15 offset:7168
    v_exp_f32 v164, v164
    v_sub_f32 v181, v198, v165
    s_waitcnt lgkmcnt(4)
    v_mfma_f32_32x32x16_bf16 v[32:47], v[72:75], a[132:135], v[32:47]
    ds_read_b128 v[64:67], v15 offset:8192
    s_add_u32 m0, s28, 8192
    s_nop 0
    buffer_load_dwordx4 v8, s[12:15], s26 offen sc1 lds
    v_sub_f32 v165, v165, v196
    v_exp_f32 v181, v181
    v_exp_f32 v165, v165
    v_mfma_f32_32x32x16_bf16 v[48:63], v[76:79], a[132:135], v[48:63]
    ds_read_b128 v[68:71], v15 offset:9216
    v_sub_f32 v182, v198, v166
    v_sub_f32 v166, v166, v196
    v_exp_f32 v182, v182
    s_waitcnt lgkmcnt(4)
    v_mfma_f32_32x32x16_bf16 v[32:47], v[80:83], a[136:139], v[32:47]
    ds_read_b128 v[72:75], v15 offset:10240
    v_exp_f32 v166, v166
    v_sub_f32 v183, v198, v167
    v_sub_f32 v167, v167, v196
    v_mfma_f32_32x32x16_bf16 v[48:63], v[84:87], a[136:139], v[48:63]
    ds_read_b128 v[76:79], v15 offset:11264
    v_exp_f32 v183, v183
    v_exp_f32 v167, v167
    s_waitcnt lgkmcnt(4)
    v_mfma_f32_32x32x16_bf16 v[32:47], v[88:91], a[140:143], v[32:47]
    ds_read_b128 v[80:83], v15 offset:12288
    buffer_load_dwordx4 v9, s[12:15], s26 offen offset:1024 sc1 lds
    s_add_u32 s26, s26, s27
    v_sub_f32 v184, v198, v168
    v_sub_f32 v168, v168, v196
    v_exp_f32 v184, v184
    v_mfma_f32_32x32x16_bf16 v[48:63], v[92:95], a[140:143], v[48:63]
    ds_read_b128 v[84:87], v15 offset:13312
    v_exp_f32 v168, v168
    v_sub_f32 v185, v198, v169
    v_sub_f32 v169, v169, v196
    v_exp_f32 v185, v185
    s_waitcnt lgkmcnt(4)
    v_mfma_f32_32x32x16_bf16 v[32:47], v[64:67], a[144:147], v[32:47]
    ds_read_b128 v[88:91], v15 offset:14336
    v_exp_f32 v169, v169
    v_sub_f32 v186, v198, v170
    v_mfma_f32_32x32x16_bf16 v[48:63], v[68:71], a[144:147], v[48:63]
    ds_read_b128 v[92:95], v15 offset:15360
    v_sub_f32 v170, v170, v196
    v_exp_f32 v186, v186
    v_exp_f32 v170, v170
    s_waitcnt lgkmcnt(4)
    v_mfma_f32_32x32x16_bf16 v[32:47], v[72:75], a[148:151], v[32:47]
    ds_read_b128 v[64:67], v15 offset:16384
    s_add_u32 m0, s28, 16384
    s_nop 0
    buffer_load_dwordx4 v8, s[12:15], s26 offen sc1 lds
    v_sub_f32 v187, v198, v171
    v_sub_f32 v171, v171, v196
    v_exp_f32 v187, v187
    v_mfma_f32_32x32x16_bf16 v[48:63], v[76:79], a[148:151], v[48:63]
    ds_read_b128 v[68:71], v15 offset:17408
    v_exp_f32 v171, v171
    v_sub_f32 v188, v198, v172
    v_sub_f32 v172, v172, v196
    s_waitcnt lgkmcnt(4)
    v_mfma_f32_32x32x16_bf16 v[32:47], v[80:83], a[152:155], v[32:47]
    ds_read_b128 v[72:75], v15 offset:18432
    v_exp_f32 v188, v188
    v_exp_f32 v172, v172
    v_mfma_f32_32x32x16_bf16 v[48:63], v[84:87], a[152:155], v[48:63]
    ds_read_b128 v[76:79], v15 offset:19456
    v_sub_f32 v189, v198, v173
    v_sub_f32 v173, v173, v196
    v_exp_f32 v189, v189
    v_exp_f32 v173, v173
    s_waitcnt lgkmcnt(4)
    v_mfma_f32_32x32x16_bf16 v[32:47], v[88:91], a[156:159], v[32:47]
    ds_read_b128 v[80:83], v15 offset:20480
    buffer_load_dwordx4 v9, s[12:15], s26 offen offset:1024 sc1 lds
    s_add_u32 s26, s26, s27
    v_sub_f32 v190, v198, v174
    v_sub_f32 v174, v174, v196
    v_exp_f32 v190, v190
    v_mfma_f32_32x32x16_bf16 v[48:63], v[92:95], a[156:159], v[48:63]
    ds_read_b128 v[84:87], v15 offset:21504
    v_exp_f32 v174, v174
    v_sub_f32 v191, v198, v175
    s_waitcnt lgkmcnt(4)
    v_mfma_f32_32x32x16_bf16 v[32:47], v[64:67], a[160:163], v[32:47]
    ds_read_b128 v[88:91], v15 offset:22528
    v_sub_f32 v175, v175, v196
    v_exp_f32 v191, v191
    v_exp_f32 v175, v175
    v_mfma_f32_32x32x16_bf16 v[48:63], v[68:71], a[160:163], v[48:63]
    ds_read_b128 v[92:95], v15 offset:23552
    v_sub_f32 v192, v198, v176
    v_sub_f32 v176, v176, v196
    v_exp_f32 v192, v192
    s_waitcnt lgkmcnt(4)
    v_mfma_f32_32x32x16_bf16 v[32:47], v[72:75], a[164:167], v[32:47]
    ds_read_b128 v[64:67], v15 offset:24576
    s_add_u32 m0, s28, 24576
    s_nop 0
    buffer_load_dwordx4 v8, s[12:15], s26 offen sc1 lds
    v_exp_f32 v176, v176
    v_sub_f32 v193, v198, v177
    v_sub_f32 v177, v177, v196
    v_mfma_f32_32x32x16_bf16 v[48:63], v[76:79], a[164:167], v[48:63]
    ds_read_b128 v[68:71], v15 offset:25600
    v_exp_f32 v193, v193
    v_exp_f32 v177, v177
    s_waitcnt lgkmcnt(4)
    v_mfma_f32_32x32x16_bf16 v[32:47], v[80:83], a[168:171], v[32:47]
    ds_read_b128 v[72:75], v15 offset:26624
    v_sub_f32 v194, v198, v178
    v_sub_f32 v178, v178, v196
    v_exp_f32 v194, v194
    v_exp_f32 v178, v178
    v_mfma_f32_32x32x16_bf16 v[48:63], v[84:87], a[168:171], v[48:63]
    ds_read_b128 v[76:79], v15 offset:27648
    v_sub_f32 v195, v198, v179
    v_sub_f32 v179, v179, v196
    v_exp_f32 v195, v195
    s_waitcnt lgkmcnt(4)
    v_mfma_f32_32x32x16_bf16 v[32:47], v[88:91], a[172:175], v[32:47]
    ds_read_b128 v[80:83], v15 offset:28672
    buffer_load_dwordx4 v9, s[12:15], s26 offen offset:1024 sc1 lds
    s_add_u32 s26, s26, s27
    v_exp_f32 v179, v179
    v_add_f32 v196, v164, v165
    v_mfma_f32_32x32x16_bf16 v[48:63], v[92:95], a[172:175], v[48:63]
    ds_read_b128 v[84:87], v15 offset:29696
    v_add_f32 v198, v180, v181
    v_add_f32 v196, v196, v166
    v_add_f32 v198, v198, v182
    v_add_f32 v196, v196, v167
    s_waitcnt lgkmcnt(4)
    v_mfma_f32_32x32x16_bf16 v[32:47], v[64:67], a[176:179], v[32:47]
    ds_read_b128 v[88:91], v15 offset:30720
    v_add_f32 v198, v198, v183
    v_add_f32 v196, v196, v168
    v_add_f32 v198, v198, v184
    v_add_f32 v196, v196, v169
    v_add_f32 v198, v198, v185
    v_mfma_f32_32x32x16_bf16 v[48:63], v[68:71], a[176:179], v[48:63]
    ds_read_b128 v[92:95], v15 offset:31744
    v_add_f32 v196, v196, v170
    v_add_f32 v198, v198, v186
    v_add_f32 v196, v196, v171
    v_add_f32 v198, v198, v187
    s_waitcnt vmcnt(8)
    s_barrier
    s_waitcnt lgkmcnt(4)
    v_mfma_f32_32x32x16_bf16 v[32:47], v[72:75], a[180:183], v[32:47]
    ds_read_b128 v[64:67], v15 offset:32768
    s_add_u32 m0, s28, 32768
    s_nop 0
    buffer_load_dwordx4 v8, s[12:15], s26 offen sc1 lds
    v_add_f32 v196, v196, v172
    v_add_f32 v198, v198, v188
    v_add_f32 v196, v196, v173
    v_add_f32 v198, v198, v189
    v_mfma_f32_32x32x16_bf16 v[48:63], v[76:79], a[180:183], v[48:63]
    ds_read_b128 v[68:71], v15 offset:33792
    v_add_f32 v196, v196, v174
    v_add_f32 v198, v198, v190
    v_add_f32 v196, v196, v175
    v_add_f32 v198, v198, v191
    v_add_f32 v196, v196, v176
    s_waitcnt lgkmcnt(4)
    v_mfma_f32_32x32x16_bf16 v[32:47], v[80:83], a[184:187], v[32:47]
    ds_read_b128 v[72:75], v15 offset:34816
    v_add_f32 v198, v198, v192
    v_add_f32 v196, v196, v177
    v_add_f32 v198, v198, v193
    v_add_f32 v196, v196, v178
    v_mfma_f32_32x32x16_bf16 v[48:63], v[84:87], a[184:187], v[48:63]
    ds_read_b128 v[76:79], v15 offset:35840
    v_add_f32 v198, v198, v194
    v_add_f32 v196, v196, v179
    v_add_f32 v198, v198, v195
    v_mov_b32 v200, v196
    s_waitcnt lgkmcnt(4)
    v_mfma_f32_32x32x16_bf16 v[32:47], v[88:91], a[188:191], v[32:47]
    ds_read_b128 v[80:83], v15 offset:36864
    buffer_load_dwordx4 v9, s[12:15], s26 offen offset:1024 sc1 lds
    s_add_u32 s26, s26, s27
    v_mov_b32 v201, v198
    s_nop 0
    v_permlane32_swap_b32 v200, v196
    v_permlane32_swap_b32 v201, v198
    v_add_f32 v196, v200, v196
    v_mfma_f32_32x32x16_bf16 v[48:63], v[92:95], a[188:191], v[48:63]
    ds_read_b128 v[84:87], v15 offset:37888
    v_add_f32 v198, v201, v198
    v_rcp_f32 v196, v196
    v_rcp_f32 v198, v198
    s_waitcnt lgkmcnt(4)
    v_mfma_f32_32x32x16_bf16 v[32:47], v[64:67], a[192:195], v[32:47]
    ds_read_b128 v[88:91], v15 offset:38912
    v_mul_f32 v164, v164, v196
    v_mul_f32 v165, v165, v196
    v_mul_f32 v166, v166, v196
    v_mfma_f32_32x32x16_bf16 v[48:63], v[68:71], a[192:195], v[48:63]
    ds_read_b128 v[92:95], v15 offset:39936
    v_mul_f32 v167, v167, v196
    v_mul_f32 v168, v168, v196
    v_mul_f32 v169, v169, v196
    v_mul_f32 v170, v170, v196
    s_waitcnt lgkmcnt(4)
    v_mfma_f32_32x32x16_bf16 v[32:47], v[72:75], a[196:199], v[32:47]
    ds_read_b128 v[64:67], v15 offset:40960
    s_add_u32 m0, s28, 40960
    s_nop 0
    buffer_load_dwordx4 v8, s[12:15], s26 offen sc1 lds
    v_mul_f32 v171, v171, v196
    v_mul_f32 v172, v172, v196
    v_mul_f32 v173, v173, v196
    v_mul_f32 v174, v174, v196
    v_mul_f32 v175, v175, v196
    v_mfma_f32_32x32x16_bf16 v[48:63], v[76:79], a[196:199], v[48:63]
    ds_read_b128 v[68:71], v15 offset:41984
    v_mul_f32 v176, v176, v196
    v_mul_f32 v177, v177, v196
    v_mul_f32 v178, v178, v196
    v_mul_f32 v179, v179, v196
    s_waitcnt lgkmcnt(4)
    v_mfma_f32_32x32x16_bf16 v[32:47], v[80:83], a[200:203], v[32:47]
    ds_read_b128 v[72:75], v15 offset:43008
    v_cvt_pk_bf16_f32 v220, v164, v165
    v_cvt_pk_bf16_f32 v221, v166, v167
    v_cvt_pk_bf16_f32 v222, v168, v169
    v_cvt_pk_bf16_f32 v223, v170, v171
    v_mfma_f32_32x32x16_bf16 v[48:63], v[84:87], a[200:203], v[48:63]
    ds_read_b128 v[76:79], v15 offset:44032
    v_cvt_pk_bf16_f32 v224, v172, v173
    v_cvt_pk_bf16_f32 v225, v174, v175
    v_cvt_pk_bf16_f32 v226, v176, v177
    v_cvt_pk_bf16_f32 v227, v178, v179
    v_mul_f32 v180, v180, v198
    s_waitcnt lgkmcnt(4)
    v_mfma_f32_32x32x16_bf16 v[32:47], v[88:91], a[204:207], v[32:47]
    ds_read_b128 v[80:83], v15 offset:45056
    buffer_load_dwordx4 v9, s[12:15], s26 offen offset:1024 sc1 lds
    s_add_u32 s26, s26, s27
    v_mul_f32 v181, v181, v198
    v_mul_f32 v182, v182, v198
    v_mul_f32 v183, v183, v198
    v_mul_f32 v184, v184, v198
    v_mfma_f32_32x32x16_bf16 v[48:63], v[92:95], a[204:207], v[48:63]
    ds_read_b128 v[84:87], v15 offset:46080
    v_mul_f32 v185, v185, v198
    v_mul_f32 v186, v186, v198
    v_mul_f32 v187, v187, v198
    v_mul_f32 v188, v188, v198
    s_waitcnt lgkmcnt(4)
    v_mfma_f32_32x32x16_bf16 v[32:47], v[64:67], a[208:211], v[32:47]
    ds_read_b128 v[88:91], v15 offset:47104
    v_mul_f32 v189, v189, v198
    v_mul_f32 v190, v190, v198
    v_mul_f32 v191, v191, v198
    v_mul_f32 v192, v192, v198
    v_mfma_f32_32x32x16_bf16 v[48:63], v[68:71], a[208:211], v[48:63]
    ds_read_b128 v[92:95], v15 offset:48128
    v_mul_f32 v193, v193, v198
    v_mul_f32 v194, v194, v198
    v_mul_f32 v195, v195, v198
    v_cvt_pk_bf16_f32 v228, v180, v181
    v_cvt_pk_bf16_f32 v229, v182, v183
    s_waitcnt lgkmcnt(4)
    v_mfma_f32_32x32x16_bf16 v[32:47], v[72:75], a[212:215], v[32:47]
    ds_read_b128 v[64:67], v15 offset:49152
    s_add_u32 m0, s28, 49152
    s_nop 0
    buffer_load_dwordx4 v8, s[12:15], s26 offen sc1 lds
    v_cvt_pk_bf16_f32 v230, v184, v185
    v_cvt_pk_bf16_f32 v231, v186, v187
    v_cvt_pk_bf16_f32 v232, v188, v189
    v_cvt_pk_bf16_f32 v233, v190, v191
    v_mfma_f32_32x32x16_bf16 v[48:63], v[76:79], a[212:215], v[48:63]
    ds_read_b128 v[68:71], v15 offset:50176
    v_cvt_pk_bf16_f32 v234, v192, v193
    v_cvt_pk_bf16_f32 v235, v194, v195
    v_lshl_add_u32 v105, v105, 3, v237
    v_xor_b32 v106, 4, v236
    s_waitcnt lgkmcnt(4)
    v_mfma_f32_32x32x16_bf16 v[32:47], v[80:83], a[216:219], v[32:47]
    ds_read_b128 v[72:75], v15 offset:51200
    v_lshl_add_u32 v106, v106, 3, v237
    v_xor_b32 v107, 6, v236
    v_lshl_add_u32 v107, v107, 3, v237
    v_xor_b32 v108, 8, v236
    v_lshl_add_u32 v108, v108, 3, v237
    v_mfma_f32_32x32x16_bf16 v[48:63], v[84:87], a[216:219], v[48:63]
    ds_read_b128 v[76:79], v15 offset:52224
    v_xor_b32 v109, 10, v236
    v_lshl_add_u32 v109, v109, 3, v237
    v_xor_b32 v110, 12, v236
    v_lshl_add_u32 v110, v110, 3, v237
    s_waitcnt lgkmcnt(4)
    v_mfma_f32_32x32x16_bf16 v[32:47], v[88:91], a[220:223], v[32:47]
    ds_read_b128 v[80:83], v15 offset:53248
    buffer_load_dwordx4 v9, s[12:15], s26 offen offset:1024 sc1 lds
    s_add_u32 s26, s26, s27
    v_xor_b32 v111, 14, v236
    v_lshl_add_u32 v111, v111, 3, v237
    v_bfe_u32 v236, v1, 2, 1
    v_lshrrev_b32 v237, 5, v1
    v_mfma_f32_32x32x16_bf16 v[48:63], v[92:95], a[220:223], v[48:63]
    ds_read_b128 v[84:87], v15 offset:54272
    v_lshl_add_u32 v236, v237, 1, v236
    v_bfe_u32 v238, v1, 3, 1
    v_lshl_add_u32 v236, v238, 3, v236
    v_bfe_u32 v238, v1, 4, 1
    v_lshlrev_b32 v238, 2, v238
    s_waitcnt lgkmcnt(4)
    v_mfma_f32_32x32x16_bf16 v[32:47], v[64:67], a[224:227], v[32:47]
    ds_read_b128 v[88:91], v15 offset:55296
    v_and_b32 v239, 3, v1
    v_add_u32 v238, v238, v239
    v_xor_b32 v236, v236, v238
    v_bfe_u32 v238, v1, 2, 2
    v_mfma_f32_32x32x16_bf16 v[48:63], v[68:71], a[224:227], v[48:63]
    ds_read_b128 v[92:95], v15 offset:56320
    v_lshl_add_u32 v237, v237, 2, v238
    v_lshlrev_b32 v237, 7, v237
    s_lshr_b32 s41, s3, 1
    s_and_b32 s42, s3, 1
    s_waitcnt lgkmcnt(4)
    v_mfma_f32_32x32x16_bf16 v[32:47], v[72:75], a[228:231], v[32:47]
    ds_read_b128 v[64:67], v15 offset:57344
    s_add_u32 m0, s28, 57344
    s_nop 0
    buffer_load_dwordx4 v8, s[12:15], s26 offen sc1 lds
    s_lshl_b32 s40, s41, 14
    s_add_u32 s40, s40, 65536
    v_add_u32 v238, s40, v237
    s_lshl_b32 s43, s42, 3
    v_mfma_f32_32x32x16_bf16 v[48:63], v[76:79], a[228:231], v[48:63]
    ds_read_b128 v[68:71], v15 offset:58368
    v_xor_b32 v239, s43, v236
    v_lshl_add_u32 v112, v239, 3, v238
    v_xor_b32 v239, 4, v239
    v_lshl_add_u32 v113, v239, 3, v238
    v_add_u32 v238, 98304, v237
    s_waitcnt lgkmcnt(4)
    v_mfma_f32_32x32x16_bf16 v[32:47], v[80:83], a[232:235], v[32:47]
    ds_read_b128 v[72:75], v15 offset:59392
    s_lshl_b32 s43, s41, 3
    v_xor_b32 v239, s43, v236
    v_lshl_add_u32 v114, v239, 3, v238
    v_xor_b32 v239, 4, v239
    v_mfma_f32_32x32x16_bf16 v[48:63], v[84:87], a[232:235], v[48:63]
    ds_read_b128 v[76:79], v15 offset:60416
    v_lshl_add_u32 v115, v239, 3, v238
    s_lshl_b32 s40, s21, 1
    s_add_u32 s40, s40, s41
    s_lshl_b32 s40, s40, 4
    s_waitcnt lgkmcnt(4)
    v_mfma_f32_32x32x16_bf16 v[32:47], v[88:91], a[236:239], v[32:47]
    ds_read_b128 v[80:83], v15 offset:61440
    buffer_load_dwordx4 v9, s[12:15], s26 offen offset:1024 sc1 lds
    s_add_u32 s26, s26, s27
    s_add_u32 s40, s40, s20
    s_lshl_b32 s40, s40, 1
    s_add_u32 s40, s40, s42
    s_lshl_b32 s41, s40, 12
    s_add_u32 s41, s41, s33
    v_mfma_f32_32x32x16_bf16 v[48:63], v[92:95], a[236:239], v[48:63]
    ds_read_b128 v[84:87], v15 offset:62464
    s_add_u32 s41, s41, 16777216
    s_lshl_b32 s42, s40, 8
    s_add_u32 s42, s42, s33
    s_add_u32 s42, s42, 20971520
    s_waitcnt lgkmcnt(4)
    v_mfma_f32_32x32x16_bf16 v[32:47], v[64:67], a[240:243], v[32:47]
    ds_read_b128 v[88:91], v15 offset:63488
    v_bfe_u32 v236, v1, 2, 1
    v_bfe_u32 v237, v1, 4, 1
    v_cmp_eq_u32 vcc, v236, v237
    v_mov_b32 v238, 0x3f803f80
    v_mfma_f32_32x32x16_bf16 v[48:63], v[68:71], a[240:243], v[48:63]
    ds_read_b128 v[92:95], v15 offset:64512
    v_cndmask_b32 v100, 0, v238, vcc
    v_mov_b32 v101, v100
    v_mov_b32 v102, v100
    v_mov_b32 v103, v100
    s_waitcnt lgkmcnt(4)
    v_mfma_f32_32x32x16_bf16 v[32:47], v[72:75], a[244:247], v[32:47]
    v_mfma_f32_32x32x16_bf16 v[48:63], v[76:79], a[244:247], v[48:63]
    s_waitcnt lgkmcnt(2)
    v_mfma_f32_32x32x16_bf16 v[32:47], v[80:83], a[248:251], v[32:47]
    v_mfma_f32_32x32x16_bf16 v[48:63], v[84:87], a[248:251], v[48:63]
    s_waitcnt lgkmcnt(0)
    v_mfma_f32_32x32x16_bf16 v[32:47], v[88:91], a[252:255], v[32:47]
    v_mfma_f32_32x32x16_bf16 v[48:63], v[92:95], a[252:255], v[48:63]
    s_nop 7
    s_nop 3
    s_setpc_b64 s[30:31]
L_ln:
    v_and_b32 v132, 31, v1
    v_lshl_add_u32 v132, v132, 3, s53
    ds_read_b64 v[136:137], v132
    ds_read_b64 v[140:141], v132 offset:256
    v_mov_b32 v138, 0
    v_mov_b32 v139, 0
    v_mov_b32 v142, 0
    v_mov_b32 v143, 0
    s_waitcnt lgkmcnt(0)
    v_mfma_f32_32x32x16_bf16 v[32:47], v[136:139], v[96:99], v[32:47]
    v_mfma_f32_32x32x16_bf16 v[48:63], v[140:143], v[96:99], v[48:63]
    s_nop 10
    v_pk_mul_f32 v[32:33], v[32:33], v[134:135] op_sel_hi:[1,0]
    v_pk_mul_f32 v[34:35], v[34:35], v[134:135] op_sel_hi:[1,0]
    v_pk_mul_f32 v[36:37], v[36:37], v[134:135] op_sel_hi:[1,0]
    v_pk_mul_f32 v[38:39], v[38:39], v[134:135] op_sel_hi:[1,0]
    v_pk_mul_f32 v[40:41], v[40:41], v[134:135] op_sel_hi:[1,0]
    v_pk_mul_f32 v[42:43], v[42:43], v[134:135] op_sel_hi:[1,0]
    v_pk_mul_f32 v[44:45], v[44:45], v[134:135] op_sel_hi:[1,0]
    v_pk_mul_f32 v[46:47], v[46:47], v[134:135] op_sel_hi:[1,0]
    v_cvt_pk_bf16_f32 v116, v32, v33
    v_cvt_pk_bf16_f32 v117, v34, v35
    v_cvt_pk_bf16_f32 v118, v36, v37
    v_cvt_pk_bf16_f32 v119, v38, v39
    v_cvt_pk_bf16_f32 v120, v40, v41
    v_cvt_pk_bf16_f32 v121, v42, v43
    v_cvt_pk_bf16_f32 v122, v44, v45
    v_cvt_pk_bf16_f32 v123, v46, v47
    v_pk_mul_f32 v[48:49], v[48:49], v[134:135] op_sel_hi:[1,0]
    v_pk_mul_f32 v[50:51], v[50:51], v[134:135] op_sel_hi:[1,0]
    v_pk_mul_f32 v[52:53], v[52:53], v[134:135] op_sel_hi:[1,0]
    v_pk_mul_f32 v[54:55], v[54:55], v[134:135] op_sel_hi:[1,0]
    v_pk_mul_f32 v[56:57], v[56:57], v[134:135] op_sel_hi:[1,0]
    v_pk_mul_f32 v[58:59], v[58:59], v[134:135] op_sel_hi:[1,0]
    v_pk_mul_f32 v[60:61], v[60:61], v[134:135] op_sel_hi:[1,0]
    v_pk_mul_f32 v[62:63], v[62:63], v[134:135] op_sel_hi:[1,0]
    v_cvt_pk_bf16_f32 v124, v48, v49
    v_cvt_pk_bf16_f32 v125, v50, v51
    v_cvt_pk_bf16_f32 v126, v52, v53
    v_cvt_pk_bf16_f32 v127, v54, v55
    v_cvt_pk_bf16_f32 v128, v56, v57
    v_cvt_pk_bf16_f32 v129, v58, v59
    v_cvt_pk_bf16_f32 v130, v60, v61
    v_cvt_pk_bf16_f32 v131, v62, v63
    s_setpc_b64 s[30:31]
L_stats:
    v_pk_add_f32 v[116:117], v[116:117], v[124:125]
    v_pk_add_f32 v[118:119], v[118:119], v[126:127]
    v_pk_add_f32 v[120:121], v[120:121], v[128:129]
    v_pk_add_f32 v[122:123], v[122:123], v[130:131]
    v_pk_add_f32 v[116:117], v[116:117], v[120:121]
    v_pk_add_f32 v[118:119], v[118:119], v[122:123]
    v_pk_add_f32 v[116:117], v[116:117], v[118:119]
    v_mov_b32 v118, v116
    s_nop 1
    v_permlane32_swap_b32 v118, v116
    v_add_f32 v116, v118, v116
    v_mov_b32 v119, v117
    s_nop 1
    v_permlane32_swap_b32 v119, v117
    v_add_f32 v117, v119, v117
    v_mul_f32 v31, 0xba800000, v116
    v_mul_f32 v117, 0x3a800000, v117
    v_fma_f32 v117, -v31, v31, v117
    v_max_f32 v117, 0, v117
    v_add_f32 v117, 0x3727c5ac, v117
    v_rsq_f32 v30, v117
    v_and_b32 v118, 0xffff0000, v31
    v_sub_f32 v119, v31, v118
    v_cvt_pk_bf16_f32 v96, v118, v118
    v_cvt_pk_bf16_f32 v97, v119, 0
    v_cmp_gt_u32 vcc, 32, v1
    s_nop 1
    v_cndmask_b32 v96, 0, v96, vcc
    v_cndmask_b32 v97, 0, v97, vcc
    v_mov_b32 v98, 0
    v_mov_b32 v99, 0
    s_setpc_b64 s[30:31]
L_x0:
    buffer_load_dwordx4 a[0:3], v2, s[4:7], s36 offen offset:0 sc1
    buffer_load_dwordx4 a[4:7], v2, s[4:7], s36 offen offset:1024 sc1
    buffer_load_dwordx4 a[8:11], v2, s[4:7], s36 offen offset:2048 sc1
    buffer_load_dwordx4 a[12:15], v2, s[4:7], s36 offen offset:3072 sc1
    s_add_u32 s36, s36, 4096
    buffer_load_dwordx4 a[16:19], v2, s[4:7], s36 offen offset:0 sc1
    buffer_load_dwordx4 a[20:23], v2, s[4:7], s36 offen offset:1024 sc1
    buffer_load_dwordx4 a[24:27], v2, s[4:7], s36 offen offset:2048 sc1
    buffer_load_dwordx4 a[28:31], v2, s[4:7], s36 offen offset:3072 sc1
    s_add_u32 s36, s36, 4096
    s_setpc_b64 s[30:31]
L_hR2:
    s_waitcnt vmcnt(4)
    v_cmp_le_u32 s[54:55], s34, v18
    s_nop 0
    s_cmp_eq_u64 s[54:55], exec
    s_cbranch_scc1 L_hR2_ok
    s_mov_b32 s56, s29
    s_mov_b32 s57, 15
    s_call_b64 s[48:49], L_poll
L_hR2_ok:
    s_lshr_b32 s40, s20, 2
    s_lshr_b32 s41, s40, 1
    s_lshl_b32 s42, s21, 1
    s_add_u32 s41, s41, s42
    s_lshl_b32 s41, s41, 5
    s_and_b32 s40, s40, 1
    s_add_u32 s41, s41, s40
    s_lshl_b32 s41, s41, 12
    s_and_b32 s40, s20, 3
    s_lshl_b32 s43, s40, 10
    s_add_u32 s41, s41, s43
    s_add_u32 s41, s41, s33
    s_add_u32 s41, s41, 16777216
    s_lshr_b32 s43, s40, 1
    s_add_u32 s43, s43, s42
    s_lshl_b32 s43, s43, 5
    s_and_b32 s40, s40, 1
    s_add_u32 s43, s43, s40
    s_lshl_b32 s43, s43, 8
    s_add_u32 s43, s43, s33
    s_add_u32 s43, s43, 20971520
    buffer_load_dwordx4 v[136:139], v2, s[4:7], s41 offen sc1
    s_add_u32 s41, s41, 8192
    buffer_load_dwordx4 v[140:143], v2, s[4:7], s41 offen sc1
    s_add_u32 s41, s41, 8192
    buffer_load_dwordx4 v[144:147], v2, s[4:7], s41 offen sc1
    s_add_u32 s41, s41, 8192
    buffer_load_dwordx4 v[148:151], v2, s[4:7], s41 offen sc1
    s_add_u32 s41, s41, 8192
    buffer_load_dwordx4 v[152:155], v2, s[4:7], s41 offen sc1
    s_add_u32 s41, s41, 8192
    buffer_load_dwordx4 v[156:159], v2, s[4:7], s41 offen sc1
    s_add_u32 s41, s41, 8192
    buffer_load_dwordx4 v[160:163], v2, s[4:7], s41 offen sc1
    s_add_u32 s41, s41, 8192
    buffer_load_dwordx4 v[164:167], v2, s[4:7], s41 offen sc1
    s_add_u32 s41, s41, 8192
    buffer_load_dwordx4 v[168:171], v2, s[4:7], s41 offen sc1
    s_add_u32 s41, s41, 8192
    buffer_load_dwordx4 v[172:175], v2, s[4:7], s41 offen sc1
    s_add_u32 s41, s41, 8192
    buffer_load_dwordx4 v[176:179], v2, s[4:7], s41 offen sc1
    s_add_u32 s41, s41, 8192
    buffer_load_dwordx4 v[180:183], v2, s[4:7], s41 offen sc1
    s_add_u32 s41, s41, 8192
    buffer_load_dwordx4 v[184:187], v2, s[4:7], s41 offen sc1
    s_add_u32 s41, s41, 8192
    buffer_load_dwordx4 v[188:191], v2, s[4:7], s41 offen sc1
    s_add_u32 s41, s41, 8192
    buffer_load_dwordx4 v[192:195], v2, s[4:7], s41 offen sc1
    s_add_u32 s41, s41, 8192
    buffer_load_dwordx4 v[196:199], v2, s[4:7], s41 offen sc1
    s_add_u32 s41, s41, 8192
    buffer_load_dword v200, v16, s[4:7], s43 offen offset:0 sc1
    buffer_load_dword v201, v16, s[4:7], s43 offen offset:512 sc1
    buffer_load_dword v202, v16, s[4:7], s43 offen offset:1024 sc1
    buffer_load_dword v203, v16, s[4:7], s43 offen offset:1536 sc1
    buffer_load_dword v204, v16, s[4:7], s43 offen offset:2048 sc1
    buffer_load_dword v205, v16, s[4:7], s43 offen offset:2560 sc1
    buffer_load_dword v206, v16, s[4:7], s43 offen offset:3072 sc1
    buffer_load_dword v207, v16, s[4:7], s43 offen offset:3584 sc1
    s_add_u32 s43, s43, 4096
    buffer_load_dword v208, v16, s[4:7], s43 offen offset:0 sc1
    buffer_load_dword v209, v16, s[4:7], s43 offen offset:512 sc1
    buffer_load_dword v210, v16, s[4:7], s43 offen offset:1024 sc1
    buffer_load_dword v211, v16, s[4:7], s43 offen offset:1536 sc1
    buffer_load_dword v212, v16, s[4:7], s43 offen offset:2048 sc1
    buffer_load_dword v213, v16, s[4:7], s43 offen offset:2560 sc1
    buffer_load_dword v214, v16, s[4:7], s43 offen offset:3072 sc1
    buffer_load_dword v215, v16, s[4:7], s43 offen offset:3584 sc1
    s_branch L_hR2_ret
L_hR1:
    v_mov_b32 v132, s34
    s_mov_b64 exec, 1
    buffer_store_dword v132, v27, s[4:7], s61 offen sc1
    s_mov_b64 exec, -1
    s_branch L_hR1_ret
L_hR3:
    s_waitcnt vmcnt(7)
    v_pk_add_f32 v[136:137], v[136:137], v[168:169]
    v_pk_add_f32 v[138:139], v[138:139], v[170:171]
    v_pk_add_f32 v[140:141], v[140:141], v[172:173]
    v_pk_add_f32 v[142:143], v[142:143], v[174:175]
    v_pk_add_f32 v[144:145], v[144:145], v[176:177]
    v_pk_add_f32 v[146:147], v[146:147], v[178:179]
    v_pk_add_f32 v[148:149], v[148:149], v[180:181]
    v_pk_add_f32 v[150:151], v[150:151], v[182:183]
    v_pk_add_f32 v[152:153], v[152:153], v[184:185]
    v_pk_add_f32 v[154:155], v[154:155], v[186:187]
    v_pk_add_f32 v[156:157], v[156:157], v[188:189]
    v_pk_add_f32 v[158:159], v[158:159], v[190:191]
    v_pk_add_f32 v[160:161], v[160:161], v[192:193]
    v_pk_add_f32 v[162:163], v[162:163], v[194:195]
    v_pk_add_f32 v[164:165], v[164:165], v[196:197]
    v_pk_add_f32 v[166:167], v[166:167], v[198:199]
    v_pk_add_f32 v[136:137], v[136:137], v[152:153]
    v_pk_add_f32 v[138:139], v[138:139], v[154:155]
    v_pk_add_f32 v[140:141], v[140:141], v[156:157]
    v_pk_add_f32 v[142:143], v[142:143], v[158:159]
    v_pk_add_f32 v[144:145], v[144:145], v[160:161]
    v_pk_add_f32 v[146:147], v[146:147], v[162:163]
    v_pk_add_f32 v[148:149], v[148:149], v[164:165]
    v_pk_add_f32 v[150:151], v[150:151], v[166:167]
    v_pk_add_f32 v[136:137], v[136:137], v[144:145]
    v_pk_add_f32 v[138:139], v[138:139], v[146:147]
    v_pk_add_f32 v[140:141], v[140:141], v[148:149]
    v_pk_add_f32 v[142:143], v[142:143], v[150:151]
    v_pk_add_f32 v[136:137], v[136:137], v[140:141]
    v_pk_add_f32 v[138:139], v[138:139], v[142:143]
    v_pk_add_f32 v[200:201], v[200:201], v[208:209]
    v_pk_add_f32 v[202:203], v[202:203], v[210:211]
    v_pk_add_f32 v[204:205], v[204:205], v[212:213]
    v_pk_add_f32 v[206:207], v[206:207], v[214:215]
    v_pk_add_f32 v[200:201], v[200:201], v[204:205]
    v_pk_add_f32 v[202:203], v[202:203], v[206:207]
    v_pk_add_f32 v[200:201], v[200:201], v[202:203]
    v_add_f32 v200, v200, v201
    v_mov_b32 v201, v200
    s_nop 1
    v_permlane32_swap_b32 v201, v200
    v_add_f32 v200, v201, v200
    v_cvt_pk_bf16_f32 v136, v136, v137
    v_cvt_pk_bf16_f32 v137, v138, v139
    v_cvt_pk_bf16_f32 v200, v200, v200
    s_lshl_b32 s40, s21, 13
    s_lshr_b32 s41, s20, 1
    s_lshl_b32 s41, s41, 10
    s_add_u32 s40, s40, s41
    s_and_b32 s41, s20, 1
    s_lshl_b32 s41, s41, 3
    s_add_u32 s40, s40, s41
    s_add_u32 s40, s40, s33
    s_add_u32 s40, s40, 22282240
    buffer_store_dwordx2 v[136:137], v2, s[4:7], s40 offen sc1
    v_bfe_u32 v132, v1, 2, 1
    v_lshlrev_b32 v132, 5, v132
    v_bfe_u32 v133, v1, 3, 2
    v_lshl_add_u32 v132, v133, 3, v132
    v_and_b32 v133, 3, v1
    v_lshl_add_u32 v132, v133, 1, v132
    s_lshl_b32 s40, s21, 8
    s_and_b32 s41, s20, 3
    s_lshl_b32 s41, s41, 6
    s_add_u32 s40, s40, s41
    s_add_u32 s40, s40, s33
    s_add_u32 s40, s40, 22544384
    s_cmp_ge_u32 s20, 4
    s_cbranch_scc1 L_hR3_ret
    buffer_store_short v200, v132, s[4:7], s40 offen sc1
    s_branch L_hR3_ret
L_grp2:
    s_add_u32 s52, s52, s28
    s_add_u32 m0, s52, 0
    s_nop 0
    buffer_load_dwordx4 v6, s[8:11], s24 offen sc1 lds
    buffer_load_dwordx4 v7, s[8:11], s24 offen offset:1024 sc1 lds
    s_add_u32 s24, s24, s25
    s_add_u32 m0, s52, 8192
    s_nop 0
    buffer_load_dwordx4 v6, s[8:11], s24 offen sc1 lds
    buffer_load_dwordx4 v7, s[8:11], s24 offen offset:1024 sc1 lds
    s_add_u32 s24, s24, s25
    s_add_u32 m0, s52, 16384
    s_nop 0
    buffer_load_dwordx4 v6, s[8:11], s24 offen sc1 lds
    buffer_load_dwordx4 v7, s[8:11], s24 offen offset:1024 sc1 lds
    s_add_u32 s24, s24, s25
    s_add_u32 m0, s52, 24576
    s_nop 0
    buffer_load_dwordx4 v6, s[8:11], s24 offen sc1 lds
    buffer_load_dwordx4 v7, s[8:11], s24 offen offset:1024 sc1 lds
    s_add_u32 s24, s24, s25
    s_add_u32 m0, s52, 32768
    s_nop 0
    buffer_load_dwordx4 v6, s[8:11], s24 offen sc1 lds
    buffer_load_dwordx4 v7, s[8:11], s24 offen offset:1024 sc1 lds
    s_add_u32 s24, s24, s25
    s_add_u32 m0, s52, 40960
    s_nop 0
    buffer_load_dwordx4 v6, s[8:11], s24 offen sc1 lds
    buffer_load_dwordx4 v7, s[8:11], s24 offen offset:1024 sc1 lds
    s_add_u32 s24, s24, s25
    s_add_u32 m0, s52, 49152
    s_nop 0
    buffer_load_dwordx4 v6, s[8:11], s24 offen sc1 lds
    buffer_load_dwordx4 v7, s[8:11], s24 offen offset:1024 sc1 lds
    s_add_u32 s24, s24, s25
    s_add_u32 m0, s52, 57344
    s_nop 0
    buffer_load_dwordx4 v6, s[8:11], s24 offen sc1 lds
    buffer_load_dwordx4 v7, s[8:11], s24 offen offset:1024 sc1 lds
    s_add_u32 s24, s24, s25
    s_setpc_b64 s[30:31]
L_xout:
    s_add_u32 s40, s23, s44
    buffer_store_dwordx4 v[240:243], v2, s[4:7], s40 offen offset:0 sc1
    buffer_store_dwordx4 v[244:247], v2, s[4:7], s40 offen offset:1024 sc1
    buffer_store_dwordx4 v[248:251], v2, s[4:7], s40 offen offset:2048 sc1
    buffer_store_dwordx4 v[252:255], v2, s[4:7], s40 offen offset:3072 sc1
    v_mov_b32 v132, 0
    v_mov_b32 v134, 0
    v_mov_b32 v133, 0
    v_mov_b32 v135, 0
    v_dot2c_f32_bf16 v132, s32, v240
    v_dot2c_f32_bf16 v133, v240, v240
    v_dot2c_f32_bf16 v134, s32, v241
    v_dot2c_f32_bf16 v135, v241, v241
    v_dot2c_f32_bf16 v132, s32, v242
    v_dot2c_f32_bf16 v133, v242, v242
    v_dot2c_f32_bf16 v134, s32, v243
    v_dot2c_f32_bf16 v135, v243, v243
    v_dot2c_f32_bf16 v132, s32, v244
    v_dot2c_f32_bf16 v133, v244, v244
    v_dot2c_f32_bf16 v134, s32, v245
    v_dot2c_f32_bf16 v135, v245, v245
    v_dot2c_f32_bf16 v132, s32, v246
    v_dot2c_f32_bf16 v133, v246, v246
    v_dot2c_f32_bf16 v134, s32, v247
    v_dot2c_f32_bf16 v135, v247, v247
    v_dot2c_f32_bf16 v132, s32, v248
    v_dot2c_f32_bf16 v133, v248, v248
    v_dot2c_f32_bf16 v134, s32, v249
    v_dot2c_f32_bf16 v135, v249, v249
    v_dot2c_f32_bf16 v132, s32, v250
    v_dot2c_f32_bf16 v133, v250, v250
    v_dot2c_f32_bf16 v134, s32, v251
    v_dot2c_f32_bf16 v135, v251, v251
    v_dot2c_f32_bf16 v132, s32, v252
    v_dot2c_f32_bf16 v133, v252, v252
    v_dot2c_f32_bf16 v134, s32, v253
    v_dot2c_f32_bf16 v135, v253, v253
    v_dot2c_f32_bf16 v132, s32, v254
    v_dot2c_f32_bf16 v133, v254, v254
    v_dot2c_f32_bf16 v134, s32, v255
    v_dot2c_f32_bf16 v135, v255, v255
    s_nop 2
    v_pk_add_f32 v[132:133], v[132:133], v[134:135]
    v_mov_b32 v134, v132
    v_mov_b32 v135, v133
    s_nop 0
    v_permlane32_swap_b32 v134, v132
    v_permlane32_swap_b32 v135, v133
    v_pk_add_f32 v[132:133], v[132:133], v[134:135]
    v_and_b32 v134, 31, v1
    v_lshlrev_b32 v134, 3, v134
    s_lshr_b32 s40, s23, 4
    s_add_u32 s40, s40, s45
    buffer_store_dwordx2 v[132:133], v134, s[4:7], s40 offen sc1
    s_setpc_b64 s[30:31]
L_poll:
    v_and_b32 v4, s57, v1
    v_lshlrev_b32 v4, 8, v4
    s_mov_b32 s35, 0
L_poll_l:
    buffer_load_dword v5, v4, s[4:7], s56 offen sc1
    s_add_u32 s35, s35, 1
    s_waitcnt vmcnt(0)
    v_cmp_le_u32 s[54:55], s34, v5
    s_nop 0
    s_cmp_eq_u64 s[54:55], exec
    s_cbranch_scc1 L_poll_d
    s_sleep 1
    s_cmp_lt_u32 s35, 0x40000
    s_cbranch_scc1 L_poll_l
    s_endpgm
L_poll_d:
    s_setpc_b64 s[48:49]
L_resid:
    v_lshlrev_b32 v132, 16, v240
    v_and_b32 v133, 0xffff0000, v240
    v_pk_add_f32 v[32:33], v[32:33], v[132:133]
    v_cvt_pk_bf16_f32 v240, v32, v33
    v_lshlrev_b32 v134, 16, v241
    v_and_b32 v135, 0xffff0000, v241
    v_pk_add_f32 v[34:35], v[34:35], v[134:135]
    v_cvt_pk_bf16_f32 v241, v34, v35
    v_lshlrev_b32 v132, 16, v242
    v_and_b32 v133, 0xffff0000, v242
    v_pk_add_f32 v[36:37], v[36:37], v[132:133]
    v_cvt_pk_bf16_f32 v242, v36, v37
    v_lshlrev_b32 v134, 16, v243
    v_and_b32 v135, 0xffff0000, v243
    v_pk_add_f32 v[38:39], v[38:39], v[134:135]
    v_cvt_pk_bf16_f32 v243, v38, v39
    v_lshlrev_b32 v132, 16, v244
    v_and_b32 v133, 0xffff0000, v244
    v_pk_add_f32 v[40:41], v[40:41], v[132:133]
    v_cvt_pk_bf16_f32 v244, v40, v41
    v_lshlrev_b32 v134, 16, v245
    v_and_b32 v135, 0xffff0000, v245
    v_pk_add_f32 v[42:43], v[42:43], v[134:135]
    v_cvt_pk_bf16_f32 v245, v42, v43
    v_lshlrev_b32 v132, 16, v246
    v_and_b32 v133, 0xffff0000, v246
    v_pk_add_f32 v[44:45], v[44:45], v[132:133]
    v_cvt_pk_bf16_f32 v246, v44, v45
    v_lshlrev_b32 v134, 16, v247
    v_and_b32 v135, 0xffff0000, v247
    v_pk_add_f32 v[46:47], v[46:47], v[134:135]
    v_cvt_pk_bf16_f32 v247, v46, v47
    v_lshlrev_b32 v132, 16, v248
    v_and_b32 v133, 0xffff0000, v248
    v_pk_add_f32 v[48:49], v[48:49], v[132:133]
    v_cvt_pk_bf16_f32 v248, v48, v49
    v_lshlrev_b32 v134, 16, v249
    v_and_b32 v135, 0xffff0000, v249
    v_pk_add_f32 v[50:51], v[50:51], v[134:135]
    v_cvt_pk_bf16_f32 v249, v50, v51
    v_lshlrev_b32 v132, 16, v250
    v_and_b32 v133, 0xffff0000, v250
    v_pk_add_f32 v[52:53], v[52:53], v[132:133]
    v_cvt_pk_bf16_f32 v250, v52, v53
    v_lshlrev_b32 v134, 16, v251
    v_and_b32 v135, 0xffff0000, v251
    v_pk_add_f32 v[54:55], v[54:55], v[134:135]
    v_cvt_pk_bf16_f32 v251, v54, v55
    v_lshlrev_b32 v132, 16, v252
    v_and_b32 v133, 0xffff0000, v252
    v_pk_add_f32 v[56:57], v[56:57], v[132:133]
    v_cvt_pk_bf16_f32 v252, v56, v57
    v_lshlrev_b32 v134, 16, v253
    v_and_b32 v135, 0xffff0000, v253
    v_pk_add_f32 v[58:59], v[58:59], v[134:135]
    v_cvt_pk_bf16_f32 v253, v58, v59
    v_lshlrev_b32 v132, 16, v254
    v_and_b32 v133, 0xffff0000, v254
    v_pk_add_f32 v[60:61], v[60:61], v[132:133]
    v_cvt_pk_bf16_f32 v254, v60, v61
    v_lshlrev_b32 v134, 16, v255
    v_and_b32 v135, 0xffff0000, v255
    v_pk_add_f32 v[62:63], v[62:63], v[134:135]
    v_cvt_pk_bf16_f32 v255, v62, v63
    s_setpc_b64 s[30:31]
L_blk4:
    v_add_u32 v136, s44, v14
    ds_read_b64_tr_b16 v[156:157], v136 offset:0
    ds_read_b64_tr_b16 v[158:159], v136 offset:1024
    ds_read_b64_tr_b16 v[160:161], v136 offset:256
    ds_read_b64_tr_b16 v[162:163], v136 offset:1280
    ds_read_b64_tr_b16 v[164:165], v136 offset:2048
    ds_read_b64_tr_b16 v[166:167], v136 offset:3072
    ds_read_b64_tr_b16 v[168:169], v136 offset:2304
    ds_read_b64_tr_b16 v[170:171], v136 offset:3328
    ds_read_b64_tr_b16 v[172:173], v136 offset:4096
    ds_read_b64_tr_b16 v[174:175], v136 offset:5120
    ds_read_b64_tr_b16 v[176:177], v136 offset:4352
    ds_read_b64_tr_b16 v[178:179], v136 offset:5376
    ds_read_b64_tr_b16 v[180:181], v136 offset:6144
    ds_read_b64_tr_b16 v[182:183], v136 offset:7168
    ds_read_b64_tr_b16 v[184:185], v136 offset:6400
    ds_read_b64_tr_b16 v[186:187], v136 offset:7424
    v_bfe_u32 v132, v1, 2, 1
    v_bfe_u32 v133, v1, 4, 1
    v_cmp_eq_u32 vcc, v132, v133
    v_mov_b32 v134, 0x3f803f80
    s_nop 0
    v_cndmask_b32 v212, 0, v134, vcc
    v_mov_b32 v213, v212
    v_mov_b32 v214, v212
    v_mov_b32 v215, v212
    s_lshl_b32 s40, s21, 17
    s_lshl_b32 s41, s20, 13
    s_add_u32 s43, s40, s41
    s_add_u32 s37, s37, s43
    s_add_u32 s42, s37, 4096
    s_waitcnt lgkmcnt(0)
    buffer_store_dwordx4 v[156:159], v2, s[4:7], s37 offen offset:0 sc1
    v_mfma_f32_16x16x32_bf16 v[204:207], v[212:215], v[156:159], 0
    buffer_store_dwordx4 v[160:163], v2, s[4:7], s37 offen offset:1024 sc1
    v_mfma_f32_16x16x32_bf16 v[208:211], v[212:215], v[160:163], 0
    buffer_store_dwordx4 v[164:167], v2, s[4:7], s37 offen offset:2048 sc1
    v_mfma_f32_16x16x32_bf16 v[204:207], v[212:215], v[164:167], v[204:207]
    buffer_store_dwordx4 v[168:171], v2, s[4:7], s37 offen offset:3072 sc1
    v_mfma_f32_16x16x32_bf16 v[208:211], v[212:215], v[168:171], v[208:211]
    buffer_store_dwordx4 v[172:175], v2, s[4:7], s42 offen offset:0 sc1
    v_mfma_f32_16x16x32_bf16 v[204:207], v[212:215], v[172:175], v[204:207]
    buffer_store_dwordx4 v[176:179], v2, s[4:7], s42 offen offset:1024 sc1
    v_mfma_f32_16x16x32_bf16 v[208:211], v[212:215], v[176:179], v[208:211]
    buffer_store_dwordx4 v[180:183], v2, s[4:7], s42 offen offset:2048 sc1
    v_mfma_f32_16x16x32_bf16 v[204:207], v[212:215], v[180:183], v[204:207]
    buffer_store_dwordx4 v[184:187], v2, s[4:7], s42 offen offset:3072 sc1
    v_mfma_f32_16x16x32_bf16 v[208:211], v[212:215], v[184:187], v[208:211]
    v_cmp_gt_u32 vcc, 32, v1
    s_lshl_b32 s40, s21, 2
    s_add_u32 s40, s40, s3
    s_lshl_b32 s40, s40, 4
    s_add_u32 s40, s40, s20
    s_lshl_b32 s40, s40, 8
    s_add_u32 s40, s40, 31522816
    s_nop 0
    v_cndmask_b32 v204, v208, v204, vcc
    buffer_store_dword v204, v16, s[4:7], s40 offen sc1
    s_setpc_b64 s[30:31]
L_blk2:
    v_add_u32 v136, s44, v14
    ds_read_b64_tr_b16 v[156:157], v136 offset:0
    ds_read_b64_tr_b16 v[158:159], v136 offset:1024
    ds_read_b64_tr_b16 v[160:161], v136 offset:256
    ds_read_b64_tr_b16 v[162:163], v136 offset:1280
    ds_read_b64_tr_b16 v[164:165], v136 offset:2048
    ds_read_b64_tr_b16 v[166:167], v136 offset:3072
    ds_read_b64_tr_b16 v[168:169], v136 offset:2304
    ds_read_b64_tr_b16 v[170:171], v136 offset:3328
    s_lshl_b32 s40, s21, 17
    s_lshl_b32 s41, s20, 13
    s_add_u32 s40, s40, s41
    s_add_u32 s38, s38, s40
    s_waitcnt lgkmcnt(0)
    buffer_store_dwordx4 v[156:159], v2, s[4:7], s38 offen offset:0 sc1
    buffer_store_dwordx4 v[160:163], v2, s[4:7], s38 offen offset:1024 sc1
    buffer_store_dwordx4 v[164:167], v2, s[4:7], s38 offen offset:2048 sc1
    buffer_store_dwordx4 v[168:171], v2, s[4:7], s38 offen offset:3072 sc1
    s_cmp_lg_u32 s3, 3
    s_cbranch_scc1 L_mtw_d
    s_cmp_ge_u32 s21, 8
    s_cbranch_scc1 L_mtw_d
    s_mov_b32 s40, 0x05040100
    s_mov_b32 s41, 0x07060302
    v_lshrrev_b32 v132, 2, v1
    v_mul_u32_u24 v132, 272, v132
    v_and_b32 v133, 3, v1
    v_lshl_add_u32 v134, v133, 2, v132
    v_and_b32 v133, 1, v1
    v_lshl_add_u32 v132, v133, 7, v132
    v_bfe_u32 v133, v1, 1, 1
    v_lshl_add_u32 v132, v133, 3, v132
    s_lshl_b32 s42, s21, 15
    s_mul_i32 s43, s20, 1088
    s_add_u32 s42, s42, s43
    s_add_u32 s42, s42, 46137344
    s_mov_b64 exec, 0xffff
    buffer_store_dword v27, v134, s[4:7], s42 offen offset:256 sc1
    v_perm_b32 v204, v222, v220, s40
    v_perm_b32 v205, v226, v224, s40
    buffer_store_dwordx2 v[204:205], v132, s[4:7], s42 offen offset:0 sc1
    v_perm_b32 v206, v222, v220, s41
    v_perm_b32 v207, v226, v224, s41
    buffer_store_dwordx2 v[206:207], v132, s[4:7], s42 offen offset:16 sc1
    v_perm_b32 v208, v223, v221, s40
    v_perm_b32 v209, v227, v225, s40
    buffer_store_dwordx2 v[208:209], v132, s[4:7], s42 offen offset:32 sc1
    v_perm_b32 v210, v223, v221, s41
    v_perm_b32 v211, v227, v225, s41
    buffer_store_dwordx2 v[210:211], v132, s[4:7], s42 offen offset:48 sc1
    v_perm_b32 v212, v230, v228, s40
    v_perm_b32 v213, v234, v232, s40
    buffer_store_dwordx2 v[212:213], v132, s[4:7], s42 offen offset:64 sc1
    v_perm_b32 v214, v230, v228, s41
    v_perm_b32 v215, v234, v232, s41
    buffer_store_dwordx2 v[214:215], v132, s[4:7], s42 offen offset:80 sc1
    v_perm_b32 v216, v231, v229, s40
    v_perm_b32 v217, v235, v233, s40
    buffer_store_dwordx2 v[216:217], v132, s[4:7], s42 offen offset:96 sc1
    v_perm_b32 v218, v231, v229, s41
    v_perm_b32 v219, v235, v233, s41
    buffer_store_dwordx2 v[218:219], v132, s[4:7], s42 offen offset:112 sc1
    s_mov_b64 exec, -1
L_mtw_d:
    s_setpc_b64 s[30:31]
L_xdma:
    s_lshl_b32 s41, s3, 15
    s_mov_b32 s40, 0
L_xdma_l:
    s_and_b32 s42, s40, 0xf0
    v_xor_b32 v4, s42, v2
    s_mov_b32 m0, s41
    s_add_u32 s41, s41, 1024
    buffer_load_dwordx4 v4, s[12:15], s45 offen lds
    s_add_u32 s45, s45, 2048
    s_add_u32 s40, s40, 16
    s_cmp_lt_u32 s40, 512
    s_cbranch_scc1 L_xdma_l
    s_setpc_b64 s[30:31]
L_usemap:
    s_lshl_b32 s22, s20, 2
    s_add_u32 s22, s22, s3
    s_lshl_b32 s23, s22, 16
    s_lshl_b32 s40, s21, 12
    s_add_u32 s23, s23, s40
    s_lshl_b32 s40, s20, 12
    s_lshl_b32 s41, s21, 8
    s_add_u32 s60, s40, s41
    s_add_u32 s60, s60, 31981568
    s_setpc_b64 s[30:31]
.section .rodata,"a"
.p2align 6
.amdhsa_kernel interleave_layers__linear_kernel_hedgehog__grouped_kv_mqa__prompt_kernel
  .amdhsa_next_free_vgpr 512
  .amdhsa_next_free_sgpr 96
  .amdhsa_accum_offset 256
  .amdhsa_group_segment_fixed_size 0
  .amdhsa_kernarg_size 96
  .amdhsa_user_sgpr_count 2
  .amdhsa_user_sgpr_kernarg_segment_ptr 1
  .amdhsa_system_sgpr_workgroup_id_x 1
.end_amdhsa_kernel
```
